```python
import torch

def _softmax(x, axis=-1):
    return torch.softmax(x, dim=axis)
def _gelu(x):
    return torch.nn.functional.gelu(x, approximate="tanh")
def _silu(x):
    return torch.nn.functional.silu(x)
def _sigmoid(x):
    return torch.sigmoid(x)
def _layernorm(x, axis=-1, eps=1e-5):
    m = x.mean(dim=axis, keepdim=True)
    v = x.var(dim=axis, keepdim=True, unbiased=False)
    return (x - m) / torch.sqrt(v + eps)
def _scatter_add(tgt, idx, src, axis=0):
    return tgt.clone().index_add_(axis, idx, src)
def _segment_sum(src, seg, n):
    out = torch.zeros((n,) + src.shape[1:], dtype=src.dtype)
    return out.index_add_(0, seg, src)
def _pad(x, pw):
    flat = tuple(v for pair in reversed(pw) for v in pair)
    return torch.nn.functional.pad(x, flat)

kernel_name = 'standalone__gqa_block_cached__near_ridge'

def setup_inputs():

    _w = (lambda a: (lambda t: t.to(torch.bfloat16) if t.is_floating_point() else t)(torch.as_tensor(a)))
    B, Sq, D = 8, 64, 576
    Hq, Hkv, Sk, Dh = 32, 16, 512, 128
    assert Hq % Hkv == 0, (Hq, Hkv)
    return {
        "x": _w((lambda *s: torch.randn(*s, dtype=torch.bfloat16) * 0.8)(B, Sq, D)),
        "k_cache": _w((lambda *s: torch.randn(*s, dtype=torch.bfloat16) * 0.8)(B, Hkv, Sk, Dh)),
        "v_cache": _w((lambda *s: torch.randn(*s, dtype=torch.bfloat16) * 0.05)(B, Hkv, Sk, Dh)),
        "wq": _w((lambda *s: torch.randn(*s, dtype=torch.bfloat16) * 0.8)(D, Hq * Dh) * (D ** -0.5)),
        "wo": _w((lambda *s: torch.randn(*s, dtype=torch.bfloat16) * 0.05)(Hq * Dh, D) * ((Hq * Dh) ** -0.5)),
    }

def reference(x, k_cache, v_cache, wq, wo):
    B, Sq, D = x.shape
    Hq, Dh = 32, 128
    Hkv = k_cache.shape[1]
    rep = Hq // Hkv
    q = (lambda x, *d: x.permute(*d))((x @ wq).reshape(B, Sq, Hq, Dh), 0, 2, 1, 3)
    k = (lambda x, n, axis: torch.repeat_interleave(x, n, dim=axis))(k_cache, rep, axis=1)
    v = (lambda x, n, axis: torch.repeat_interleave(x, n, dim=axis))(v_cache, rep, axis=1)
    scores = torch.einsum("bhqd,bhkd->bhqk", q, k) * (Dh ** -0.5)
    p = _softmax(scores, axis=-1)
    o = torch.einsum("bhqk,bhkd->bhqd", p, v)
    return (lambda x, *d: x.permute(*d))(o, 0, 2, 1, 3).reshape(B, Sq, Hq * Dh) @ wo
```

```asm
; @launch grid=(256,1,1) block=(512,1,1) lds=163840
.amdgcn_target "amdgcn-amd-amdhsa--gfx950"
.text
.globl standalone__gqa_block_cached__near_ridge_kernel
.p2align 8
.type standalone__gqa_block_cached__near_ridge_kernel,@function
standalone__gqa_block_cached__near_ridge_kernel:
s_getpc_b64 s[36:37]
K_pc:
s_load_dwordx4 s[4:7], s[0:1], 0
s_load_dwordx4 s[8:11], s[0:1], 16
s_load_dwordx4 s[12:15], s[0:1], 32
s_load_dwordx4 s[32:35], s[0:1], 48
s_cmp_ge_u32 s2, 256
s_cbranch_scc1 K_end

v_lshlrev_b32 v250, 7, v0
v_mov_b32 v251, s37
v_add_co_u32 v250, vcc, s36, v250
v_lshrrev_b32 v1, 6, v0
v_and_b32 v2, 63, v0
v_addc_co_u32 v251, vcc, 0, v251, vcc
v_cmp_gt_u32 vcc, (K_codeend-K_pc+127)/128, v0
v_readfirstlane_b32 s16, v1
s_and_saveexec_b64 s[38:39], vcc
s_cbranch_execz K_nopf
global_load_dword v252, v[250:251], off

K_nopf:
s_mov_b64 exec, s[38:39]
s_and_b32 s19, s2, 7
s_lshr_b32 s28, s2, 3
s_and_b32 s31, s28, 3
s_lshl_b32 s18, s19, 2
s_add_u32 s18, s18, s31
s_lshr_b32 s17, s2, 5
s_cmp_lt_u32 s16, 4
s_cbranch_scc1 K_compute

s_sub_u32 s30, s16, 4
v_lshrrev_b32 v7, 4, v2
v_and_b32 v16, 15, v2
s_cmp_eq_u32 s30, 3
s_cbranch_scc1 K_kload
s_cmp_eq_u32 s30, 0
s_cbranch_scc1 K_xsetup

v_lshlrev_b32 v17, 2, v7
v_xor_b32 v16, v16, v17
v_lshlrev_b32 v16, 4, v16
v_lshl_add_u32 v20, v7, 13, v16

v_add_u32 v21, 31744, v20
v_add_u32 v22, 63488, v20
v_add_u32 v23, 95232, v20
v_add_u32 v24, 131072, v20
v_add_u32 v25, 162816, v20
v_add_u32 v26, 194560, v20
v_add_u32 v27, 226304, v20
s_sub_u32 s29, s30, 1
s_lshl_b32 s40, s18, 8
s_lshl_b32 s28, s29, 18
s_add_u32 s40, s40, s28
s_lshl_b32 s42, s29, 13
s_add_u32 s42, s42, 65536
s_mov_b32 s41, 524288
s_mov_b32 s43, 16384
s_waitcnt lgkmcnt(0)
s_mov_b32 s20, s10
s_mov_b32 s21, s11
s_mov_b32 s22, 4718592
s_branch K_asetup

K_xsetup:
v_lshrrev_b32 v5, 3, v2
v_mul_u32_u24 v5, 1152, v5
v_and_b32 v6, 7, v2
v_xor_b32 v6, v6, v7
v_lshl_add_u32 v20, v6, 4, v5
v_xor_b32 v6, 4, v6
v_lshl_add_u32 v21, v6, 4, v5

v_add_u32 v27, 61440, v21
v_add_u32 v26, 53248, v20
v_add_u32 v25, 45056, v21
v_add_u32 v24, 36864, v20
v_add_u32 v23, 24576, v21
v_add_u32 v22, 16384, v20
v_add_u32 v21, 8192, v21
s_mul_i32 s40, s17, 73728
s_mov_b32 s42, 131072
s_mov_b32 s41, 128
s_mov_b32 s43, 8192
s_waitcnt lgkmcnt(0)
s_mov_b32 s20, s4
s_mov_b32 s21, s5
s_mov_b32 s22, 589824

K_asetup:
s_mov_b32 s23, 0x20000
s_mov_b32 s44, 0
s_add_u32 s44, s31, s17
s_mul_i32 s28, s44, 11
s_lshr_b32 s28, s28, 5
s_mul_i32 s28, s28, 3
s_sub_u32 s44, s44, s28
s_mul_i32 s44, s44, 3
s_mul_i32 s28, s44, s41
s_add_u32 s40, s40, s28

s_mul_i32 s47, s41, 9
s_mul_i32 s48, s43, 4
s_mov_b32 s45, 0
s_mov_b32 s46, 0

A_loop:
s_cmp_lt_u32 s45, 3
s_cbranch_scc1 A_issue
s_waitcnt vmcnt(16)

s_barrier
A_issue:
s_mov_b32 m0, s42
s_add_u32 s28, s42, 4096
buffer_load_dwordx4 v20, s[20:23], s40 offen offset:0  lds
buffer_load_dwordx4 v21, s[20:23], s40 offen offset:1024  lds
buffer_load_dwordx4 v22, s[20:23], s40 offen offset:2048  lds
buffer_load_dwordx4 v23, s[20:23], s40 offen offset:3072  lds
s_mov_b32 m0, s28
s_add_u32 s44, s44, 1
buffer_load_dwordx4 v24, s[20:23], s40 offen offset:0  lds
buffer_load_dwordx4 v25, s[20:23], s40 offen offset:1024  lds
buffer_load_dwordx4 v26, s[20:23], s40 offen offset:2048  lds
buffer_load_dwordx4 v27, s[20:23], s40 offen offset:3072  lds
s_add_u32 s40, s40, s41
s_cmp_lt_u32 s44, 9
s_cbranch_scc1 A_nowrap
s_mov_b32 s44, 0
s_sub_u32 s40, s40, s47

A_nowrap:
s_add_u32 s42, s42, s43
s_add_u32 s46, s46, 1
s_cmp_lt_u32 s46, 4
s_cbranch_scc1 A_nowrap2
s_mov_b32 s46, 0
s_sub_u32 s42, s42, s48

A_nowrap2:
s_add_u32 s45, s45, 1
s_cmp_lt_u32 s45, 9
s_cbranch_scc1 A_loop

v_lshrrev_b32 v7, 4, v2
v_and_b32 v6, 15, v2
v_lshlrev_b32 v5, 8, v7
v_xor_b32 v9, v6, v7
v_lshl_add_u32 v10, v9, 4, v5
v_xor_b32 v11, 0x40, v10
v_xor_b32 v12, 0x80, v10
v_xor_b32 v13, 0xc0, v10
v_lshlrev_b32 v9, 2, v7
v_xor_b32 v6, v6, v9
v_lshl_add_u32 v8, v6, 4, v5
s_lshr_b32 s28, s18, 1
s_lshl_b32 s40, s17, 4
s_add_u32 s40, s40, s28
s_lshl_b32 s40, s40, 17
s_and_b32 s44, s18, 1
s_lshl_b32 s44, s44, 16
s_waitcnt lgkmcnt(0)
s_mov_b32 s20, s6
s_mov_b32 s21, s7
s_mov_b32 s22, 0x1000000
s_mov_b32 s23, 0x20000
s_mov_b32 s24, s8
s_mov_b32 s25, s9
s_mov_b32 s26, 0x1000000
s_mov_b32 s27, 0x20000

s_waitcnt vmcnt(16)
s_barrier
s_waitcnt vmcnt(8)
s_barrier
s_waitcnt vmcnt(0)
s_barrier
s_branch K_common
K_kload:
v_lshrrev_b32 v7, 4, v2
v_and_b32 v6, 15, v2
v_lshlrev_b32 v5, 8, v7
v_xor_b32 v9, v6, v7
v_lshl_add_u32 v10, v9, 4, v5
v_xor_b32 v11, 0x40, v10
v_xor_b32 v12, 0x80, v10
v_xor_b32 v13, 0xc0, v10
v_lshlrev_b32 v9, 2, v7
v_xor_b32 v6, v6, v9
v_lshl_add_u32 v8, v6, 4, v5
s_lshr_b32 s28, s18, 1
s_lshl_b32 s40, s17, 4
s_add_u32 s40, s40, s28
s_lshl_b32 s40, s40, 17
s_and_b32 s44, s18, 1
s_lshl_b32 s44, s44, 16
s_waitcnt lgkmcnt(0)
s_mov_b32 s20, s6
s_mov_b32 s21, s7
s_mov_b32 s22, 0x1000000
s_mov_b32 s23, 0x20000
s_mov_b32 s24, s8
s_mov_b32 s25, s9
s_mov_b32 s26, 0x1000000
s_mov_b32 s27, 0x20000

s_barrier
s_barrier
s_barrier
s_add_u32 s28, s44, 0
s_and_b32 s28, s28, 0x1ffff
s_add_u32 s28, s28, s40
s_mov_b32 m0, 0
s_nop 0
buffer_load_dwordx4 v10, s[20:23], s28 offen offset:0  lds
buffer_load_dwordx4 v11, s[20:23], s28 offen offset:1024  lds
buffer_load_dwordx4 v12, s[20:23], s28 offen offset:2048  lds
buffer_load_dwordx4 v13, s[20:23], s28 offen offset:3072  lds
s_mov_b32 m0, 4096
s_add_u32 s28, s28, 4096
buffer_load_dwordx4 v10, s[20:23], s28 offen offset:0  lds
buffer_load_dwordx4 v11, s[20:23], s28 offen offset:1024  lds
buffer_load_dwordx4 v12, s[20:23], s28 offen offset:2048  lds
buffer_load_dwordx4 v13, s[20:23], s28 offen offset:3072  lds
s_mov_b32 m0, 8192
s_add_u32 s28, s28, 4096
buffer_load_dwordx4 v10, s[20:23], s28 offen offset:0  lds
buffer_load_dwordx4 v11, s[20:23], s28 offen offset:1024  lds
buffer_load_dwordx4 v12, s[20:23], s28 offen offset:2048  lds
buffer_load_dwordx4 v13, s[20:23], s28 offen offset:3072  lds
s_mov_b32 m0, 12288
s_add_u32 s28, s28, 4096
buffer_load_dwordx4 v10, s[20:23], s28 offen offset:0  lds
buffer_load_dwordx4 v11, s[20:23], s28 offen offset:1024  lds
buffer_load_dwordx4 v12, s[20:23], s28 offen offset:2048  lds
buffer_load_dwordx4 v13, s[20:23], s28 offen offset:3072  lds
s_barrier
s_barrier
s_add_u32 s28, s44, 16384
s_and_b32 s28, s28, 0x1ffff
s_add_u32 s28, s28, s40
s_mov_b32 m0, 16384
s_nop 0
buffer_load_dwordx4 v10, s[20:23], s28 offen offset:0  lds
buffer_load_dwordx4 v11, s[20:23], s28 offen offset:1024  lds
buffer_load_dwordx4 v12, s[20:23], s28 offen offset:2048  lds
buffer_load_dwordx4 v13, s[20:23], s28 offen offset:3072  lds
s_mov_b32 m0, 20480
s_add_u32 s28, s28, 4096
buffer_load_dwordx4 v10, s[20:23], s28 offen offset:0  lds
buffer_load_dwordx4 v11, s[20:23], s28 offen offset:1024  lds
buffer_load_dwordx4 v12, s[20:23], s28 offen offset:2048  lds
buffer_load_dwordx4 v13, s[20:23], s28 offen offset:3072  lds
s_mov_b32 m0, 24576
s_add_u32 s28, s28, 4096
buffer_load_dwordx4 v10, s[20:23], s28 offen offset:0  lds
buffer_load_dwordx4 v11, s[20:23], s28 offen offset:1024  lds
buffer_load_dwordx4 v12, s[20:23], s28 offen offset:2048  lds
buffer_load_dwordx4 v13, s[20:23], s28 offen offset:3072  lds
s_mov_b32 m0, 28672
s_add_u32 s28, s28, 4096
buffer_load_dwordx4 v10, s[20:23], s28 offen offset:0  lds
buffer_load_dwordx4 v11, s[20:23], s28 offen offset:1024  lds
buffer_load_dwordx4 v12, s[20:23], s28 offen offset:2048  lds
buffer_load_dwordx4 v13, s[20:23], s28 offen offset:3072  lds
s_barrier
s_barrier
s_add_u32 s28, s44, 32768
s_and_b32 s28, s28, 0x1ffff
s_add_u32 s28, s28, s40
s_mov_b32 m0, 32768
s_nop 0
buffer_load_dwordx4 v10, s[20:23], s28 offen offset:0  lds
buffer_load_dwordx4 v11, s[20:23], s28 offen offset:1024  lds
buffer_load_dwordx4 v12, s[20:23], s28 offen offset:2048  lds
buffer_load_dwordx4 v13, s[20:23], s28 offen offset:3072  lds
s_mov_b32 m0, 36864
s_add_u32 s28, s28, 4096
buffer_load_dwordx4 v10, s[20:23], s28 offen offset:0  lds
buffer_load_dwordx4 v11, s[20:23], s28 offen offset:1024  lds
buffer_load_dwordx4 v12, s[20:23], s28 offen offset:2048  lds
buffer_load_dwordx4 v13, s[20:23], s28 offen offset:3072  lds
s_mov_b32 m0, 40960
s_add_u32 s28, s28, 4096
buffer_load_dwordx4 v10, s[20:23], s28 offen offset:0  lds
buffer_load_dwordx4 v11, s[20:23], s28 offen offset:1024  lds
buffer_load_dwordx4 v12, s[20:23], s28 offen offset:2048  lds
buffer_load_dwordx4 v13, s[20:23], s28 offen offset:3072  lds
s_mov_b32 m0, 45056
s_add_u32 s28, s28, 4096
buffer_load_dwordx4 v10, s[20:23], s28 offen offset:0  lds
buffer_load_dwordx4 v11, s[20:23], s28 offen offset:1024  lds
buffer_load_dwordx4 v12, s[20:23], s28 offen offset:2048  lds
buffer_load_dwordx4 v13, s[20:23], s28 offen offset:3072  lds
s_barrier
s_barrier
s_add_u32 s28, s44, 49152
s_and_b32 s28, s28, 0x1ffff
s_add_u32 s28, s28, s40
s_mov_b32 m0, 49152
s_nop 0
buffer_load_dwordx4 v10, s[20:23], s28 offen offset:0  lds
buffer_load_dwordx4 v11, s[20:23], s28 offen offset:1024  lds
buffer_load_dwordx4 v12, s[20:23], s28 offen offset:2048  lds
buffer_load_dwordx4 v13, s[20:23], s28 offen offset:3072  lds
s_mov_b32 m0, 53248
s_add_u32 s28, s28, 4096
buffer_load_dwordx4 v10, s[20:23], s28 offen offset:0  lds
buffer_load_dwordx4 v11, s[20:23], s28 offen offset:1024  lds
buffer_load_dwordx4 v12, s[20:23], s28 offen offset:2048  lds
buffer_load_dwordx4 v13, s[20:23], s28 offen offset:3072  lds
s_mov_b32 m0, 57344
s_add_u32 s28, s28, 4096
buffer_load_dwordx4 v10, s[20:23], s28 offen offset:0  lds
buffer_load_dwordx4 v11, s[20:23], s28 offen offset:1024  lds
buffer_load_dwordx4 v12, s[20:23], s28 offen offset:2048  lds
buffer_load_dwordx4 v13, s[20:23], s28 offen offset:3072  lds
s_mov_b32 m0, 61440
s_add_u32 s28, s28, 4096
buffer_load_dwordx4 v10, s[20:23], s28 offen offset:0  lds
buffer_load_dwordx4 v11, s[20:23], s28 offen offset:1024  lds
buffer_load_dwordx4 v12, s[20:23], s28 offen offset:2048  lds
buffer_load_dwordx4 v13, s[20:23], s28 offen offset:3072  lds
K_common:
s_lshl_b32 s43, s30, 12
s_add_u32 s41, s40, s43
s_waitcnt vmcnt(48)
s_barrier
s_add_u32 s28, s44, 65536
s_and_b32 s28, s28, 0x1ffff
s_add_u32 m0, s43, 65536
s_add_u32 s28, s28, s41
buffer_load_dwordx4 v10, s[20:23], s28 offen offset:0  lds
buffer_load_dwordx4 v11, s[20:23], s28 offen offset:1024  lds
buffer_load_dwordx4 v12, s[20:23], s28 offen offset:2048  lds
buffer_load_dwordx4 v13, s[20:23], s28 offen offset:3072  lds
s_add_u32 s28, s44, 81920
s_and_b32 s28, s28, 0x1ffff
s_add_u32 m0, s43, 81920
s_add_u32 s28, s28, s41
buffer_load_dwordx4 v10, s[20:23], s28 offen offset:0  lds
buffer_load_dwordx4 v11, s[20:23], s28 offen offset:1024  lds
buffer_load_dwordx4 v12, s[20:23], s28 offen offset:2048  lds
buffer_load_dwordx4 v13, s[20:23], s28 offen offset:3072  lds
s_add_u32 s28, s44, 98304
s_and_b32 s28, s28, 0x1ffff
s_add_u32 m0, s43, 98304
s_add_u32 s28, s28, s41
buffer_load_dwordx4 v10, s[20:23], s28 offen offset:0  lds
buffer_load_dwordx4 v11, s[20:23], s28 offen offset:1024  lds
buffer_load_dwordx4 v12, s[20:23], s28 offen offset:2048  lds
buffer_load_dwordx4 v13, s[20:23], s28 offen offset:3072  lds
s_add_u32 s28, s44, 114688
s_and_b32 s28, s28, 0x1ffff
s_add_u32 m0, s43, 114688
s_add_u32 s28, s28, s41
buffer_load_dwordx4 v10, s[20:23], s28 offen offset:0  lds
buffer_load_dwordx4 v11, s[20:23], s28 offen offset:1024  lds
buffer_load_dwordx4 v12, s[20:23], s28 offen offset:2048  lds
buffer_load_dwordx4 v13, s[20:23], s28 offen offset:3072  lds
s_waitcnt vmcnt(48)
s_barrier
s_mov_b32 s28, 0
s_add_u32 m0, s43, 0
s_add_u32 s28, s28, s41
buffer_load_dwordx4 v8, s[24:27], s28 offen offset:0  lds
buffer_load_dwordx4 v8, s[24:27], s28 offen offset:1024  lds
buffer_load_dwordx4 v8, s[24:27], s28 offen offset:2048  lds
buffer_load_dwordx4 v8, s[24:27], s28 offen offset:3072  lds
s_waitcnt vmcnt(36)
s_barrier
s_mov_b32 s28, 16384
s_add_u32 m0, s43, 16384
s_add_u32 s28, s28, s41
buffer_load_dwordx4 v8, s[24:27], s28 offen offset:0  lds
buffer_load_dwordx4 v8, s[24:27], s28 offen offset:1024  lds
buffer_load_dwordx4 v8, s[24:27], s28 offen offset:2048  lds
buffer_load_dwordx4 v8, s[24:27], s28 offen offset:3072  lds
s_waitcnt vmcnt(24)
s_barrier
s_mov_b32 s28, 32768
s_add_u32 m0, s43, 32768
s_add_u32 s28, s28, s41
buffer_load_dwordx4 v8, s[24:27], s28 offen offset:0  lds
buffer_load_dwordx4 v8, s[24:27], s28 offen offset:1024  lds
buffer_load_dwordx4 v8, s[24:27], s28 offen offset:2048  lds
buffer_load_dwordx4 v8, s[24:27], s28 offen offset:3072  lds
s_waitcnt vmcnt(24)
s_barrier
s_mov_b32 s28, 49152
s_add_u32 m0, s43, 49152
s_add_u32 s28, s28, s41
buffer_load_dwordx4 v8, s[24:27], s28 offen offset:0  lds
buffer_load_dwordx4 v8, s[24:27], s28 offen offset:1024  lds
buffer_load_dwordx4 v8, s[24:27], s28 offen offset:2048  lds
buffer_load_dwordx4 v8, s[24:27], s28 offen offset:3072  lds
s_waitcnt vmcnt(24)
s_barrier
s_waitcnt vmcnt(20)
s_barrier
s_waitcnt vmcnt(16)
s_barrier
s_waitcnt vmcnt(12)
s_barrier
v_mov_b32 v19, 156672
ds_read_b32 v19, v19
s_waitcnt lgkmcnt(0)
v_readfirstlane_b32 s50, v19
s_mov_b32 s28, 65536
s_add_u32 m0, s43, 65536
s_add_u32 s28, s28, s41
buffer_load_dwordx4 v8, s[24:27], s28 offen offset:0  lds
buffer_load_dwordx4 v8, s[24:27], s28 offen offset:1024  lds
buffer_load_dwordx4 v8, s[24:27], s28 offen offset:2048  lds
buffer_load_dwordx4 v8, s[24:27], s28 offen offset:3072  lds
s_waitcnt vmcnt(12)
s_barrier
s_mov_b32 s28, 81920
s_add_u32 m0, s43, 81920
s_add_u32 s28, s28, s41
buffer_load_dwordx4 v8, s[24:27], s28 offen offset:0  lds
buffer_load_dwordx4 v8, s[24:27], s28 offen offset:1024  lds
buffer_load_dwordx4 v8, s[24:27], s28 offen offset:2048  lds
buffer_load_dwordx4 v8, s[24:27], s28 offen offset:3072  lds
s_waitcnt vmcnt(12)
s_barrier
s_mov_b32 s28, 98304
s_add_u32 m0, s43, 98304
s_add_u32 s28, s28, s41
buffer_load_dwordx4 v8, s[24:27], s28 offen offset:0  lds
buffer_load_dwordx4 v8, s[24:27], s28 offen offset:1024  lds
buffer_load_dwordx4 v8, s[24:27], s28 offen offset:2048  lds
buffer_load_dwordx4 v8, s[24:27], s28 offen offset:3072  lds
s_waitcnt vmcnt(12)
s_barrier
s_mov_b32 s28, 114688
s_add_u32 m0, s43, 114688
s_add_u32 s28, s28, s41
buffer_load_dwordx4 v8, s[24:27], s28 offen offset:0  lds
buffer_load_dwordx4 v8, s[24:27], s28 offen offset:1024  lds
buffer_load_dwordx4 v8, s[24:27], s28 offen offset:2048  lds
buffer_load_dwordx4 v8, s[24:27], s28 offen offset:3072  lds
s_mov_b32 s20, s12
s_mov_b32 s21, s13
s_mov_b32 s22, 4718592
v_lshrrev_b32 v7, 4, v2
v_and_b32 v6, 15, v2
v_mul_u32_u24 v5, 1152, v7
v_lshlrev_b32 v16, 1, v7
v_xor_b32 v16, v6, v16
v_lshl_add_u32 v20, v16, 4, v5
v_xor_b32 v16, 8, v16
v_lshl_add_u32 v21, v16, 4, v5
v_add_u32 v22, 7168, v20
v_add_u32 v23, 10752, v21
v_add_u32 v21, 3584, v21
v_lshrrev_b32 v5, 3, v2
v_mul_u32_u24 v5, 1152, v5
v_and_b32 v6, 7, v2
v_lshlrev_b32 v16, 1, v7
v_xor_b32 v6, v6, v16
v_lshl_add_u32 v24, v6, 4, v5
v_add_u32 v25, 8192, v24
v_add_u32 v26, 16384, v24
v_add_u32 v27, 24576, v24
s_mul_i32 s45, s19, 589824
s_lshl_b32 s28, s31, 8
s_add_u32 s46, s45, s28
s_mul_i32 s28, s30, 18432
s_add_u32 s46, s46, s28
s_lshl_b32 s49, s31, 7
s_mul_i32 s28, s31, 147456
s_add_u32 s45, s45, s28
s_mul_i32 s28, s30, 36864
s_add_u32 s45, s45, s28
s_add_u32 s45, s45, 1024

s_add_u32 m0, s43, 131072
s_nop 0
buffer_load_dwordx4 v24, s[20:23], s45 offen offset:0  lds
buffer_load_dwordx4 v25, s[20:23], s45 offen offset:1024  lds
buffer_load_dwordx4 v26, s[20:23], s45 offen offset:2048  lds
buffer_load_dwordx4 v27, s[20:23], s45 offen offset:3072  lds
s_waitcnt vmcnt(16)
s_barrier
s_add_u32 s28, s49, 0
s_and_b32 s28, s28, 511
s_mul_i32 s28, s28, 1152
s_add_u32 m0, s43, 0
s_add_u32 s28, s28, s46
buffer_load_dwordx4 v20, s[20:23], s28 offen offset:0  lds
buffer_load_dwordx4 v21, s[20:23], s28 offen offset:1024  lds
buffer_load_dwordx4 v22, s[20:23], s28 offen offset:2048  lds
buffer_load_dwordx4 v23, s[20:23], s28 offen offset:3072  lds
s_waitcnt vmcnt(16)
s_barrier
s_add_u32 s28, s49, 64
s_and_b32 s28, s28, 511
s_mul_i32 s28, s28, 1152
s_add_u32 m0, s43, 16384
s_add_u32 s28, s28, s46
buffer_load_dwordx4 v20, s[20:23], s28 offen offset:0  lds
buffer_load_dwordx4 v21, s[20:23], s28 offen offset:1024  lds
buffer_load_dwordx4 v22, s[20:23], s28 offen offset:2048  lds
buffer_load_dwordx4 v23, s[20:23], s28 offen offset:3072  lds
s_add_u32 s28, s49, 128
s_and_b32 s28, s28, 511
s_mul_i32 s28, s28, 1152
s_add_u32 m0, s43, 32768
s_add_u32 s28, s28, s46
buffer_load_dwordx4 v20, s[20:23], s28 offen offset:0  lds
buffer_load_dwordx4 v21, s[20:23], s28 offen offset:1024  lds
buffer_load_dwordx4 v22, s[20:23], s28 offen offset:2048  lds
buffer_load_dwordx4 v23, s[20:23], s28 offen offset:3072  lds
s_waitcnt vmcnt(20)
s_barrier
s_add_u32 s28, s49, 192
s_and_b32 s28, s28, 511
s_mul_i32 s28, s28, 1152
s_add_u32 m0, s43, 49152
s_add_u32 s28, s28, s46
buffer_load_dwordx4 v20, s[20:23], s28 offen offset:0  lds
buffer_load_dwordx4 v21, s[20:23], s28 offen offset:1024  lds
buffer_load_dwordx4 v22, s[20:23], s28 offen offset:2048  lds
buffer_load_dwordx4 v23, s[20:23], s28 offen offset:3072  lds
s_waitcnt vmcnt(20)
s_barrier
s_add_u32 s28, s49, 256
s_and_b32 s28, s28, 511
s_mul_i32 s28, s28, 1152
s_add_u32 m0, s43, 65536
s_add_u32 s28, s28, s46
buffer_load_dwordx4 v20, s[20:23], s28 offen offset:0  lds
buffer_load_dwordx4 v21, s[20:23], s28 offen offset:1024  lds
buffer_load_dwordx4 v22, s[20:23], s28 offen offset:2048  lds
buffer_load_dwordx4 v23, s[20:23], s28 offen offset:3072  lds
s_barrier
s_barrier
s_add_u32 s28, s49, 320
s_and_b32 s28, s28, 511
s_mul_i32 s28, s28, 1152
s_add_u32 m0, s43, 81920
s_add_u32 s28, s28, s46
buffer_load_dwordx4 v20, s[20:23], s28 offen offset:0  lds
buffer_load_dwordx4 v21, s[20:23], s28 offen offset:1024  lds
buffer_load_dwordx4 v22, s[20:23], s28 offen offset:2048  lds
buffer_load_dwordx4 v23, s[20:23], s28 offen offset:3072  lds
s_add_u32 s28, s49, 384
s_and_b32 s28, s28, 511
s_mul_i32 s28, s28, 1152
s_add_u32 m0, s43, 98304
s_add_u32 s28, s28, s46
buffer_load_dwordx4 v20, s[20:23], s28 offen offset:0  lds
buffer_load_dwordx4 v21, s[20:23], s28 offen offset:1024  lds
buffer_load_dwordx4 v22, s[20:23], s28 offen offset:2048  lds
buffer_load_dwordx4 v23, s[20:23], s28 offen offset:3072  lds
s_add_u32 s28, s49, 448
s_and_b32 s28, s28, 511
s_mul_i32 s28, s28, 1152
s_add_u32 m0, s43, 114688
s_add_u32 s28, s28, s46
buffer_load_dwordx4 v20, s[20:23], s28 offen offset:0  lds
buffer_load_dwordx4 v21, s[20:23], s28 offen offset:1024  lds
buffer_load_dwordx4 v22, s[20:23], s28 offen offset:2048  lds
buffer_load_dwordx4 v23, s[20:23], s28 offen offset:3072  lds
s_waitcnt vmcnt(12)
s_barrier
s_waitcnt vmcnt(0)
s_barrier
s_endpgm
.p2align 6
K_compute:
s_memrealtime s[48:49]
s_waitcnt lgkmcnt(0)
s_or_b32 s48, s48, 8
s_and_b32 s48, s48, 0xfffffff8
s_or_b32 s28, s16, s2
s_cmp_lg_u32 s28, 0
s_cbranch_scc1 K_nononce
v_mov_b32 v246, s48
v_mov_b32 v248, 0
v_cmp_eq_u32 vcc, 0, v2
s_and_saveexec_b64 s[38:39], vcc
global_store_dword v248, v246, s[32:33] sc1
s_mov_b64 exec, s[38:39]

K_nononce:
s_mov_b32 s20, s34
s_mov_b32 s21, s35
s_mov_b32 s22, 67108864
s_mov_b32 s23, 0x20000
s_lshl_b32 s28, s17, 3
s_add_u32 s28, s28, s19
s_lshl_b32 s28, s28, 7
s_add_u32 s51, s28, 16908288
s_add_u32 s52, s28, 16777216
s_and_b32 s30, s16, 1
s_lshr_b32 s47, s16, 1
s_lshl_b32 s28, s30, 11
s_lshl_b32 s29, s47, 13
s_add_u32 s98, s28, s29
s_lshl_b32 s29, s17, 5
s_add_u32 s29, s29, s18
s_lshl_b32 s29, s29, 14
s_add_u32 s96, s98, s29
s_add_u32 s97, s96, 4096
s_lshl_b32 s99, s17, 5
s_lshl_b32 s28, s19, 2
s_add_u32 s99, s99, s28
s_lshl_b32 s99, s99, 14
s_lshl_b32 s28, s30, 11
s_add_u32 s99, s99, s28
s_lshl_b32 s28, s19, 3
s_add_u32 s28, s28, s17
s_lshl_b32 s28, s28, 2
s_add_u32 s28, s28, s31
s_mul_i32 s28, s28, 24576
s_add_u32 s28, s28, 4194304
s_lshl_b32 s29, s16, 12
s_add_u32 s100, s28, s29
s_lshl_b32 s29, s16, 11
s_add_u32 s101, s28, s29
s_add_u32 s101, s101, 16384

s_and_b32 s30, s16, 1
s_lshr_b32 s47, s16, 1
v_and_b32 v3, 31, v2
v_lshrrev_b32 v4, 5, v2
v_lshrrev_b32 v5, 4, v2
v_and_b32 v6, 15, v2
v_lshrrev_b32 v7, 2, v6
v_and_b32 v8, 3, v2
s_lshl_b32 s28, s30, 5
v_add_u32 v9, s28, v3
v_lshrrev_b32 v10, 1, v9
v_and_b32 v10, 7, v10
v_xor_b32 v10, v4, v10
v_lshlrev_b32 v10, 4, v10
v_lshl_add_u32 v10, v9, 7, v10
v_lshrrev_b32 v13, 1, v5
v_lshl_add_u32 v13, v13, 3, v7
v_lshlrev_b32 v13, 8, v13
v_and_b32 v14, 1, v5
v_lshl_add_u32 v13, v14, 5, v13
v_and_b32 v14, 1, v8
v_lshl_add_u32 v15, v14, 4, v13
v_lshrrev_b32 v14, 1, v8
v_lshl_add_u32 v15, v14, 3, v15
s_lshl_b32 s28, s47, 1
v_xor_b32 v14, s28, v7
v_lshl_add_u32 v11, v14, 6, v15
v_xor_b32 v14, 1, v14
v_lshl_add_u32 v12, v14, 6, v15

v_xor_b32 v64, 0, v10
v_add_u32 v64, 131072, v64
v_xor_b32 v65, 32, v10
v_add_u32 v65, 131072, v65
v_xor_b32 v66, 64, v10
v_add_u32 v66, 131072, v66
v_xor_b32 v67, 96, v10
v_add_u32 v67, 131072, v67
v_add_u32 v68, 65536, v11
v_add_u32 v69, 65536, v12
s_barrier
ds_read_b128 v[48:51], v64 offset:0
ds_read_b64_tr_b16 v[16:17], v68 offset:0
ds_read_b64_tr_b16 v[18:19], v68 offset:1024
ds_read_b64_tr_b16 v[32:33], v69 offset:0
ds_read_b64_tr_b16 v[34:35], v69 offset:1024
ds_read_b128 v[52:55], v65 offset:0
ds_read_b64_tr_b16 v[20:21], v68 offset:4096
ds_read_b64_tr_b16 v[22:23], v68 offset:5120
ds_read_b64_tr_b16 v[36:37], v69 offset:4096
ds_read_b64_tr_b16 v[38:39], v69 offset:5120
ds_read_b128 v[56:59], v66 offset:0
ds_read_b64_tr_b16 v[24:25], v68 offset:8192
ds_read_b64_tr_b16 v[26:27], v68 offset:9216
ds_read_b64_tr_b16 v[40:41], v69 offset:8192
ds_read_b64_tr_b16 v[42:43], v69 offset:9216
s_waitcnt lgkmcnt(10)
v_mfma_f32_32x32x16_bf16 v[128:143], v[16:19], v[48:51], 0
ds_read_b128 v[60:63], v67 offset:0
ds_read_b64_tr_b16 v[28:29], v68 offset:12288
ds_read_b64_tr_b16 v[30:31], v68 offset:13312
v_mfma_f32_32x32x16_bf16 v[144:159], v[32:35], v[48:51], 0
ds_read_b64_tr_b16 v[44:45], v69 offset:12288
ds_read_b64_tr_b16 v[46:47], v69 offset:13312
s_waitcnt lgkmcnt(10)
v_mfma_f32_32x32x16_bf16 v[128:143], v[20:23], v[52:55], v[128:143]
v_mfma_f32_32x32x16_bf16 v[144:159], v[36:39], v[52:55], v[144:159]
s_waitcnt lgkmcnt(5)
v_mfma_f32_32x32x16_bf16 v[128:143], v[24:27], v[56:59], v[128:143]
v_mfma_f32_32x32x16_bf16 v[144:159], v[40:43], v[56:59], v[144:159]
s_waitcnt lgkmcnt(0)
v_mfma_f32_32x32x16_bf16 v[128:143], v[28:31], v[60:63], v[128:143]
v_mfma_f32_32x32x16_bf16 v[144:159], v[44:47], v[60:63], v[144:159]
s_barrier
ds_read_b128 v[48:51], v64 offset:8192
ds_read_b64_tr_b16 v[16:17], v68 offset:16384
ds_read_b64_tr_b16 v[18:19], v68 offset:17408
ds_read_b64_tr_b16 v[32:33], v69 offset:16384
ds_read_b64_tr_b16 v[34:35], v69 offset:17408
ds_read_b128 v[52:55], v65 offset:8192
ds_read_b64_tr_b16 v[20:21], v68 offset:20480
ds_read_b64_tr_b16 v[22:23], v68 offset:21504
ds_read_b64_tr_b16 v[36:37], v69 offset:20480
ds_read_b64_tr_b16 v[38:39], v69 offset:21504
ds_read_b128 v[56:59], v66 offset:8192
ds_read_b64_tr_b16 v[24:25], v68 offset:24576
ds_read_b64_tr_b16 v[26:27], v68 offset:25600
ds_read_b64_tr_b16 v[40:41], v69 offset:24576
ds_read_b64_tr_b16 v[42:43], v69 offset:25600
s_waitcnt lgkmcnt(10)
v_mfma_f32_32x32x16_bf16 v[128:143], v[16:19], v[48:51], v[128:143]
ds_read_b128 v[60:63], v67 offset:8192
ds_read_b64_tr_b16 v[28:29], v68 offset:28672
ds_read_b64_tr_b16 v[30:31], v68 offset:29696
v_mfma_f32_32x32x16_bf16 v[144:159], v[32:35], v[48:51], v[144:159]
ds_read_b64_tr_b16 v[44:45], v69 offset:28672
ds_read_b64_tr_b16 v[46:47], v69 offset:29696
s_waitcnt lgkmcnt(10)
v_mfma_f32_32x32x16_bf16 v[128:143], v[20:23], v[52:55], v[128:143]
v_mfma_f32_32x32x16_bf16 v[144:159], v[36:39], v[52:55], v[144:159]
s_waitcnt lgkmcnt(5)
v_mfma_f32_32x32x16_bf16 v[128:143], v[24:27], v[56:59], v[128:143]
v_mfma_f32_32x32x16_bf16 v[144:159], v[40:43], v[56:59], v[144:159]
s_waitcnt lgkmcnt(0)
v_mfma_f32_32x32x16_bf16 v[128:143], v[28:31], v[60:63], v[128:143]
v_mfma_f32_32x32x16_bf16 v[144:159], v[44:47], v[60:63], v[144:159]
s_barrier
ds_read_b128 v[48:51], v64 offset:16384
ds_read_b64_tr_b16 v[16:17], v68 offset:32768
ds_read_b64_tr_b16 v[18:19], v68 offset:33792
ds_read_b64_tr_b16 v[32:33], v69 offset:32768
ds_read_b64_tr_b16 v[34:35], v69 offset:33792
ds_read_b128 v[52:55], v65 offset:16384
ds_read_b64_tr_b16 v[20:21], v68 offset:36864
ds_read_b64_tr_b16 v[22:23], v68 offset:37888
ds_read_b64_tr_b16 v[36:37], v69 offset:36864
ds_read_b64_tr_b16 v[38:39], v69 offset:37888
ds_read_b128 v[56:59], v66 offset:16384
ds_read_b64_tr_b16 v[24:25], v68 offset:40960
ds_read_b64_tr_b16 v[26:27], v68 offset:41984
ds_read_b64_tr_b16 v[40:41], v69 offset:40960
ds_read_b64_tr_b16 v[42:43], v69 offset:41984
s_waitcnt lgkmcnt(10)
v_mfma_f32_32x32x16_bf16 v[128:143], v[16:19], v[48:51], v[128:143]
ds_read_b128 v[60:63], v67 offset:16384
ds_read_b64_tr_b16 v[28:29], v68 offset:45056
ds_read_b64_tr_b16 v[30:31], v68 offset:46080
v_mfma_f32_32x32x16_bf16 v[144:159], v[32:35], v[48:51], v[144:159]
ds_read_b64_tr_b16 v[44:45], v69 offset:45056
ds_read_b64_tr_b16 v[46:47], v69 offset:46080
s_waitcnt lgkmcnt(10)
v_mfma_f32_32x32x16_bf16 v[128:143], v[20:23], v[52:55], v[128:143]
v_mfma_f32_32x32x16_bf16 v[144:159], v[36:39], v[52:55], v[144:159]
s_waitcnt lgkmcnt(5)
v_mfma_f32_32x32x16_bf16 v[128:143], v[24:27], v[56:59], v[128:143]
v_mfma_f32_32x32x16_bf16 v[144:159], v[40:43], v[56:59], v[144:159]
s_waitcnt lgkmcnt(0)
v_mfma_f32_32x32x16_bf16 v[128:143], v[28:31], v[60:63], v[128:143]
v_mfma_f32_32x32x16_bf16 v[144:159], v[44:47], v[60:63], v[144:159]
s_barrier
ds_read_b128 v[48:51], v64 offset:24576
ds_read_b64_tr_b16 v[16:17], v68 offset:49152
ds_read_b64_tr_b16 v[18:19], v68 offset:50176
ds_read_b64_tr_b16 v[32:33], v69 offset:49152
ds_read_b64_tr_b16 v[34:35], v69 offset:50176
ds_read_b128 v[52:55], v65 offset:24576
ds_read_b64_tr_b16 v[20:21], v68 offset:53248
ds_read_b64_tr_b16 v[22:23], v68 offset:54272
ds_read_b64_tr_b16 v[36:37], v69 offset:53248
ds_read_b64_tr_b16 v[38:39], v69 offset:54272
ds_read_b128 v[56:59], v66 offset:24576
ds_read_b64_tr_b16 v[24:25], v68 offset:57344
ds_read_b64_tr_b16 v[26:27], v68 offset:58368
ds_read_b64_tr_b16 v[40:41], v69 offset:57344
ds_read_b64_tr_b16 v[42:43], v69 offset:58368
s_waitcnt lgkmcnt(10)
v_mfma_f32_32x32x16_bf16 v[128:143], v[16:19], v[48:51], v[128:143]
ds_read_b128 v[60:63], v67 offset:24576
ds_read_b64_tr_b16 v[28:29], v68 offset:61440
ds_read_b64_tr_b16 v[30:31], v68 offset:62464
v_mfma_f32_32x32x16_bf16 v[144:159], v[32:35], v[48:51], v[144:159]
ds_read_b64_tr_b16 v[44:45], v69 offset:61440
ds_read_b64_tr_b16 v[46:47], v69 offset:62464
s_waitcnt lgkmcnt(10)
v_mfma_f32_32x32x16_bf16 v[128:143], v[20:23], v[52:55], v[128:143]
v_mfma_f32_32x32x16_bf16 v[144:159], v[36:39], v[52:55], v[144:159]
s_waitcnt lgkmcnt(5)
v_mfma_f32_32x32x16_bf16 v[128:143], v[24:27], v[56:59], v[128:143]
v_mfma_f32_32x32x16_bf16 v[144:159], v[40:43], v[56:59], v[144:159]
s_waitcnt lgkmcnt(0)
v_mfma_f32_32x32x16_bf16 v[128:143], v[28:31], v[60:63], v[128:143]
v_mfma_f32_32x32x16_bf16 v[144:159], v[44:47], v[60:63], v[144:159]
s_barrier
ds_read_b128 v[48:51], v64 offset:0
ds_read_b64_tr_b16 v[16:17], v68 offset:0
ds_read_b64_tr_b16 v[18:19], v68 offset:1024
ds_read_b64_tr_b16 v[32:33], v69 offset:0
ds_read_b64_tr_b16 v[34:35], v69 offset:1024
ds_read_b128 v[52:55], v65 offset:0
ds_read_b64_tr_b16 v[20:21], v68 offset:4096
ds_read_b64_tr_b16 v[22:23], v68 offset:5120
ds_read_b64_tr_b16 v[36:37], v69 offset:4096
ds_read_b64_tr_b16 v[38:39], v69 offset:5120
ds_read_b128 v[56:59], v66 offset:0
ds_read_b64_tr_b16 v[24:25], v68 offset:8192
ds_read_b64_tr_b16 v[26:27], v68 offset:9216
ds_read_b64_tr_b16 v[40:41], v69 offset:8192
ds_read_b64_tr_b16 v[42:43], v69 offset:9216
s_waitcnt lgkmcnt(10)
v_mfma_f32_32x32x16_bf16 v[128:143], v[16:19], v[48:51], v[128:143]
ds_read_b128 v[60:63], v67 offset:0
ds_read_b64_tr_b16 v[28:29], v68 offset:12288
ds_read_b64_tr_b16 v[30:31], v68 offset:13312
v_mfma_f32_32x32x16_bf16 v[144:159], v[32:35], v[48:51], v[144:159]
ds_read_b64_tr_b16 v[44:45], v69 offset:12288
ds_read_b64_tr_b16 v[46:47], v69 offset:13312
s_waitcnt lgkmcnt(10)
v_mfma_f32_32x32x16_bf16 v[128:143], v[20:23], v[52:55], v[128:143]
v_mfma_f32_32x32x16_bf16 v[144:159], v[36:39], v[52:55], v[144:159]
s_waitcnt lgkmcnt(5)
v_mfma_f32_32x32x16_bf16 v[128:143], v[24:27], v[56:59], v[128:143]
v_mfma_f32_32x32x16_bf16 v[144:159], v[40:43], v[56:59], v[144:159]
s_waitcnt lgkmcnt(0)
v_mfma_f32_32x32x16_bf16 v[128:143], v[28:31], v[60:63], v[128:143]
v_mfma_f32_32x32x16_bf16 v[144:159], v[44:47], v[60:63], v[144:159]
s_barrier
v_mov_b32 v248, 0
global_load_dword v246, v248, s[32:33] sc1
ds_read_b128 v[48:51], v64 offset:8192
ds_read_b64_tr_b16 v[16:17], v68 offset:16384
ds_read_b64_tr_b16 v[18:19], v68 offset:17408
ds_read_b64_tr_b16 v[32:33], v69 offset:16384
ds_read_b64_tr_b16 v[34:35], v69 offset:17408
ds_read_b128 v[52:55], v65 offset:8192
ds_read_b64_tr_b16 v[20:21], v68 offset:20480
ds_read_b64_tr_b16 v[22:23], v68 offset:21504
ds_read_b64_tr_b16 v[36:37], v69 offset:20480
ds_read_b64_tr_b16 v[38:39], v69 offset:21504
ds_read_b128 v[56:59], v66 offset:8192
ds_read_b64_tr_b16 v[24:25], v68 offset:24576
ds_read_b64_tr_b16 v[26:27], v68 offset:25600
ds_read_b64_tr_b16 v[40:41], v69 offset:24576
ds_read_b64_tr_b16 v[42:43], v69 offset:25600
s_waitcnt lgkmcnt(10)
v_mfma_f32_32x32x16_bf16 v[128:143], v[16:19], v[48:51], v[128:143]
ds_read_b128 v[60:63], v67 offset:8192
ds_read_b64_tr_b16 v[28:29], v68 offset:28672
ds_read_b64_tr_b16 v[30:31], v68 offset:29696
v_mfma_f32_32x32x16_bf16 v[144:159], v[32:35], v[48:51], v[144:159]
ds_read_b64_tr_b16 v[44:45], v69 offset:28672
ds_read_b64_tr_b16 v[46:47], v69 offset:29696
s_waitcnt lgkmcnt(10)
v_mfma_f32_32x32x16_bf16 v[128:143], v[20:23], v[52:55], v[128:143]
v_mfma_f32_32x32x16_bf16 v[144:159], v[36:39], v[52:55], v[144:159]
s_waitcnt lgkmcnt(5)
v_mfma_f32_32x32x16_bf16 v[128:143], v[24:27], v[56:59], v[128:143]
v_mfma_f32_32x32x16_bf16 v[144:159], v[40:43], v[56:59], v[144:159]
s_waitcnt lgkmcnt(0)
v_mfma_f32_32x32x16_bf16 v[128:143], v[28:31], v[60:63], v[128:143]
v_mfma_f32_32x32x16_bf16 v[144:159], v[44:47], v[60:63], v[144:159]
s_barrier
ds_read_b128 v[48:51], v64 offset:16384
ds_read_b64_tr_b16 v[16:17], v68 offset:32768
ds_read_b64_tr_b16 v[18:19], v68 offset:33792
ds_read_b64_tr_b16 v[32:33], v69 offset:32768
ds_read_b64_tr_b16 v[34:35], v69 offset:33792
ds_read_b128 v[52:55], v65 offset:16384
ds_read_b64_tr_b16 v[20:21], v68 offset:36864
ds_read_b64_tr_b16 v[22:23], v68 offset:37888
ds_read_b64_tr_b16 v[36:37], v69 offset:36864
ds_read_b64_tr_b16 v[38:39], v69 offset:37888
ds_read_b128 v[56:59], v66 offset:16384
ds_read_b64_tr_b16 v[24:25], v68 offset:40960
ds_read_b64_tr_b16 v[26:27], v68 offset:41984
ds_read_b64_tr_b16 v[40:41], v69 offset:40960
ds_read_b64_tr_b16 v[42:43], v69 offset:41984
s_waitcnt lgkmcnt(10)
v_mfma_f32_32x32x16_bf16 v[128:143], v[16:19], v[48:51], v[128:143]
ds_read_b128 v[60:63], v67 offset:16384
ds_read_b64_tr_b16 v[28:29], v68 offset:45056
ds_read_b64_tr_b16 v[30:31], v68 offset:46080
v_mfma_f32_32x32x16_bf16 v[144:159], v[32:35], v[48:51], v[144:159]
ds_read_b64_tr_b16 v[44:45], v69 offset:45056
ds_read_b64_tr_b16 v[46:47], v69 offset:46080
s_waitcnt lgkmcnt(10)
v_mfma_f32_32x32x16_bf16 v[128:143], v[20:23], v[52:55], v[128:143]
v_mfma_f32_32x32x16_bf16 v[144:159], v[36:39], v[52:55], v[144:159]
s_waitcnt lgkmcnt(5)
v_mfma_f32_32x32x16_bf16 v[128:143], v[24:27], v[56:59], v[128:143]
v_mfma_f32_32x32x16_bf16 v[144:159], v[40:43], v[56:59], v[144:159]
s_waitcnt lgkmcnt(0)
v_mfma_f32_32x32x16_bf16 v[128:143], v[28:31], v[60:63], v[128:143]
v_mfma_f32_32x32x16_bf16 v[144:159], v[44:47], v[60:63], v[144:159]
s_barrier
ds_read_b128 v[48:51], v64 offset:24576
ds_read_b64_tr_b16 v[16:17], v68 offset:49152
ds_read_b64_tr_b16 v[18:19], v68 offset:50176
ds_read_b64_tr_b16 v[32:33], v69 offset:49152
ds_read_b64_tr_b16 v[34:35], v69 offset:50176
ds_read_b128 v[52:55], v65 offset:24576
ds_read_b64_tr_b16 v[20:21], v68 offset:53248
ds_read_b64_tr_b16 v[22:23], v68 offset:54272
ds_read_b64_tr_b16 v[36:37], v69 offset:53248
ds_read_b64_tr_b16 v[38:39], v69 offset:54272
ds_read_b128 v[56:59], v66 offset:24576
ds_read_b64_tr_b16 v[24:25], v68 offset:57344
ds_read_b64_tr_b16 v[26:27], v68 offset:58368
ds_read_b64_tr_b16 v[40:41], v69 offset:57344
ds_read_b64_tr_b16 v[42:43], v69 offset:58368
s_waitcnt lgkmcnt(10)
v_mfma_f32_32x32x16_bf16 v[128:143], v[16:19], v[48:51], v[128:143]
ds_read_b128 v[60:63], v67 offset:24576
ds_read_b64_tr_b16 v[28:29], v68 offset:61440
ds_read_b64_tr_b16 v[30:31], v68 offset:62464
v_mfma_f32_32x32x16_bf16 v[144:159], v[32:35], v[48:51], v[144:159]
ds_read_b64_tr_b16 v[44:45], v69 offset:61440
ds_read_b64_tr_b16 v[46:47], v69 offset:62464
s_waitcnt lgkmcnt(10)
v_mfma_f32_32x32x16_bf16 v[128:143], v[20:23], v[52:55], v[128:143]
v_mfma_f32_32x32x16_bf16 v[144:159], v[36:39], v[52:55], v[144:159]
s_waitcnt lgkmcnt(5)
v_mfma_f32_32x32x16_bf16 v[128:143], v[24:27], v[56:59], v[128:143]
v_mfma_f32_32x32x16_bf16 v[144:159], v[40:43], v[56:59], v[144:159]
s_waitcnt lgkmcnt(0)
v_mfma_f32_32x32x16_bf16 v[128:143], v[28:31], v[60:63], v[128:143]
v_mfma_f32_32x32x16_bf16 v[144:159], v[44:47], v[60:63], v[144:159]
s_barrier
ds_read_b128 v[48:51], v64 offset:0
ds_read_b64_tr_b16 v[16:17], v68 offset:0
ds_read_b64_tr_b16 v[18:19], v68 offset:1024
ds_read_b64_tr_b16 v[32:33], v69 offset:0
ds_read_b64_tr_b16 v[34:35], v69 offset:1024
ds_read_b128 v[52:55], v65 offset:0
ds_read_b64_tr_b16 v[20:21], v68 offset:4096
ds_read_b64_tr_b16 v[22:23], v68 offset:5120
ds_read_b64_tr_b16 v[36:37], v69 offset:4096
ds_read_b64_tr_b16 v[38:39], v69 offset:5120
ds_read_b128 v[56:59], v66 offset:0
ds_read_b64_tr_b16 v[24:25], v68 offset:8192
ds_read_b64_tr_b16 v[26:27], v68 offset:9216
ds_read_b64_tr_b16 v[40:41], v69 offset:8192
ds_read_b64_tr_b16 v[42:43], v69 offset:9216
s_waitcnt lgkmcnt(10)
v_mfma_f32_32x32x16_bf16 v[128:143], v[16:19], v[48:51], v[128:143]
ds_read_b128 v[60:63], v67 offset:0
ds_read_b64_tr_b16 v[28:29], v68 offset:12288
ds_read_b64_tr_b16 v[30:31], v68 offset:13312
v_mfma_f32_32x32x16_bf16 v[144:159], v[32:35], v[48:51], v[144:159]
ds_read_b64_tr_b16 v[44:45], v69 offset:12288
ds_read_b64_tr_b16 v[46:47], v69 offset:13312
s_waitcnt lgkmcnt(10)
v_mfma_f32_32x32x16_bf16 v[128:143], v[20:23], v[52:55], v[128:143]
v_mfma_f32_32x32x16_bf16 v[144:159], v[36:39], v[52:55], v[144:159]
s_waitcnt lgkmcnt(5)
v_mfma_f32_32x32x16_bf16 v[128:143], v[24:27], v[56:59], v[128:143]
v_mfma_f32_32x32x16_bf16 v[144:159], v[40:43], v[56:59], v[144:159]
s_waitcnt lgkmcnt(0)
v_mfma_f32_32x32x16_bf16 v[128:143], v[28:31], v[60:63], v[128:143]
v_mfma_f32_32x32x16_bf16 v[144:159], v[44:47], v[60:63], v[144:159]
s_lshl_b32 s28, s47, 5
v_add_u32 v10, s28, v3
v_and_b32 v11, 15, v10
v_xor_b32 v11, v4, v11
v_lshlrev_b32 v11, 4, v11
v_lshl_add_u32 v10, v10, 8, v11
v_lshlrev_b32 v9, 4, v2
s_lshl_b32 s28, s16, 12
v_add_u32 v13, s28, v9
v_add_u32 v13, 139264, v13
s_lshl_b32 s28, s30, 12
v_add_u32 v12, s28, v9
v_add_u32 v12, 139264, v12
s_waitcnt vmcnt(0)

v_xor_b32 v80, 0, v10
v_xor_b32 v81, 32, v10
v_xor_b32 v82, 64, v10
v_xor_b32 v83, 96, v10
v_xor_b32 v84, 128, v10
v_xor_b32 v85, 160, v10
v_xor_b32 v86, 192, v10
v_xor_b32 v87, 224, v10
v_add_u32 v88, 65536, v80
v_add_u32 v89, 65536, v81
v_add_u32 v90, 65536, v82
v_add_u32 v91, 65536, v83
v_add_u32 v92, 65536, v84
v_add_u32 v93, 65536, v85
v_add_u32 v94, 65536, v86
v_add_u32 v95, 65536, v87
s_cmp_lg_u32 s16, 0
s_cbranch_scc1 K_nononce2
s_mov_b32 s45, 0
K_nonce_chk:
v_readfirstlane_b32 s28, v246
s_cmp_lg_u32 s28, 0
s_cbranch_scc1 K_nonce_ok
s_add_u32 s45, s45, 1
s_cmp_gt_u32 s45, 0x40000
s_cbranch_scc1 K_nonce_ok
global_load_dword v246, v248, s[32:33] sc1
s_waitcnt vmcnt(0)
s_branch K_nonce_chk

K_nonce_ok:
v_mov_b32 v247, 156672
v_cmp_eq_u32 vcc, 0, v2
s_and_saveexec_b64 s[38:39], vcc
ds_write_b32 v247, v246
s_getreg_b32 s28, hwreg(HW_REG_XCC_ID, 0, 4)
s_and_b32 s28, s28, 7
v_or_b32 v246, s28, v246
s_lshl_b32 s28, s31, 2
v_mov_b32 v247, s28
buffer_store_dword v246, v247, s[20:23], s51 offen sc1
s_mov_b64 exec, s[38:39]

K_nononce2:
v_cvt_pk_bf16_f32 v16, v128, v129
v_cvt_pk_bf16_f32 v17, v130, v131
v_cvt_pk_bf16_f32 v18, v132, v133
v_cvt_pk_bf16_f32 v19, v134, v135
v_cvt_pk_bf16_f32 v20, v136, v137
v_cvt_pk_bf16_f32 v21, v138, v139
v_cvt_pk_bf16_f32 v22, v140, v141
v_cvt_pk_bf16_f32 v23, v142, v143
v_cvt_pk_bf16_f32 v24, v144, v145
v_cvt_pk_bf16_f32 v25, v146, v147
v_cvt_pk_bf16_f32 v26, v148, v149
v_cvt_pk_bf16_f32 v27, v150, v151
v_cvt_pk_bf16_f32 v28, v152, v153
v_cvt_pk_bf16_f32 v29, v154, v155
v_cvt_pk_bf16_f32 v30, v156, v157
v_cvt_pk_bf16_f32 v31, v158, v159
ds_write_b128 v13, v[16:19] offset:0
ds_write_b128 v13, v[20:23] offset:1024
ds_write_b128 v13, v[24:27] offset:2048
ds_write_b128 v13, v[28:31] offset:3072
s_waitcnt lgkmcnt(0)
s_bitcmp1_b32 s18, 0
s_cbranch_scc1 K_kphase_b
s_barrier
ds_read_b128 v[96:99], v12 offset:0
ds_read_b128 v[100:103], v12 offset:1024
ds_read_b128 v[104:107], v12 offset:2048
ds_read_b128 v[108:111], v12 offset:3072
ds_read_b128 v[112:115], v12 offset:8192
ds_read_b128 v[116:119], v12 offset:9216
ds_read_b128 v[120:123], v12 offset:10240
ds_read_b128 v[124:127], v12 offset:11264
ds_read_b128 v[16:19], v80 offset:0
ds_read_b128 v[20:23], v81 offset:0
ds_read_b128 v[24:27], v82 offset:0
ds_read_b128 v[28:31], v83 offset:0
s_waitcnt lgkmcnt(8)
ds_read_b128 v[32:35], v84 offset:0
ds_read_b128 v[36:39], v85 offset:0
ds_read_b128 v[40:43], v86 offset:0
ds_read_b128 v[44:47], v87 offset:0
s_waitcnt lgkmcnt(0)
s_barrier
ds_read_b128 v[48:51], v80 offset:16384
ds_read_b128 v[52:55], v81 offset:16384
v_mfma_f32_32x32x16_bf16 v[128:143], v[16:19], v[96:99], 0
ds_read_b128 v[56:59], v82 offset:16384
ds_read_b128 v[60:63], v83 offset:16384
v_mfma_f32_32x32x16_bf16 v[128:143], v[20:23], v[100:103], v[128:143]
ds_read_b128 v[64:67], v84 offset:16384
ds_read_b128 v[68:71], v85 offset:16384
v_mfma_f32_32x32x16_bf16 v[128:143], v[24:27], v[104:107], v[128:143]
ds_read_b128 v[72:75], v86 offset:16384
ds_read_b128 v[76:79], v87 offset:16384
v_mfma_f32_32x32x16_bf16 v[128:143], v[28:31], v[108:111], v[128:143]
v_mfma_f32_32x32x16_bf16 v[128:143], v[32:35], v[112:115], v[128:143]
v_mfma_f32_32x32x16_bf16 v[128:143], v[36:39], v[116:119], v[128:143]
v_mfma_f32_32x32x16_bf16 v[128:143], v[40:43], v[120:123], v[128:143]
v_mfma_f32_32x32x16_bf16 v[128:143], v[44:47], v[124:127], v[128:143]
s_waitcnt lgkmcnt(0)
s_barrier
ds_read_b128 v[16:19], v80 offset:32768
ds_read_b128 v[20:23], v81 offset:32768
v_mfma_f32_32x32x16_bf16 v[144:159], v[48:51], v[96:99], 0
ds_read_b128 v[24:27], v82 offset:32768
ds_read_b128 v[28:31], v83 offset:32768
v_mfma_f32_32x32x16_bf16 v[144:159], v[52:55], v[100:103], v[144:159]
ds_read_b128 v[32:35], v84 offset:32768
ds_read_b128 v[36:39], v85 offset:32768
v_mfma_f32_32x32x16_bf16 v[144:159], v[56:59], v[104:107], v[144:159]
ds_read_b128 v[40:43], v86 offset:32768
ds_read_b128 v[44:47], v87 offset:32768
v_mfma_f32_32x32x16_bf16 v[144:159], v[60:63], v[108:111], v[144:159]
v_max_f32 v15, v128, v129
v_max3_f32 v15, v15, v130, v131
v_mfma_f32_32x32x16_bf16 v[144:159], v[64:67], v[112:115], v[144:159]
v_max3_f32 v15, v15, v132, v133
v_max3_f32 v15, v15, v134, v135
v_mfma_f32_32x32x16_bf16 v[144:159], v[68:71], v[116:119], v[144:159]
v_max3_f32 v15, v15, v136, v137
v_max3_f32 v15, v15, v138, v139
v_mfma_f32_32x32x16_bf16 v[144:159], v[72:75], v[120:123], v[144:159]
v_max3_f32 v15, v15, v140, v141
v_max3_f32 v15, v15, v142, v143
v_mfma_f32_32x32x16_bf16 v[144:159], v[76:79], v[124:127], v[144:159]
s_waitcnt lgkmcnt(0)
s_barrier
ds_read_b128 v[48:51], v80 offset:49152
ds_read_b128 v[52:55], v81 offset:49152
v_mfma_f32_32x32x16_bf16 v[160:175], v[16:19], v[96:99], 0
ds_read_b128 v[56:59], v82 offset:49152
ds_read_b128 v[60:63], v83 offset:49152
v_mfma_f32_32x32x16_bf16 v[160:175], v[20:23], v[100:103], v[160:175]
ds_read_b128 v[64:67], v84 offset:49152
ds_read_b128 v[68:71], v85 offset:49152
v_mfma_f32_32x32x16_bf16 v[160:175], v[24:27], v[104:107], v[160:175]
ds_read_b128 v[72:75], v86 offset:49152
ds_read_b128 v[76:79], v87 offset:49152
v_mfma_f32_32x32x16_bf16 v[160:175], v[28:31], v[108:111], v[160:175]
v_max3_f32 v15, v15, v144, v145
v_max3_f32 v15, v15, v146, v147
v_mfma_f32_32x32x16_bf16 v[160:175], v[32:35], v[112:115], v[160:175]
v_max3_f32 v15, v15, v148, v149
v_max3_f32 v15, v15, v150, v151
v_mfma_f32_32x32x16_bf16 v[160:175], v[36:39], v[116:119], v[160:175]
v_max3_f32 v15, v15, v152, v153
v_max3_f32 v15, v15, v154, v155
v_mfma_f32_32x32x16_bf16 v[160:175], v[40:43], v[120:123], v[160:175]
v_max3_f32 v15, v15, v156, v157
v_max3_f32 v15, v15, v158, v159
v_mfma_f32_32x32x16_bf16 v[160:175], v[44:47], v[124:127], v[160:175]
s_waitcnt lgkmcnt(0)
s_barrier
ds_read_b128 v[16:19], v88 offset:0
ds_read_b128 v[20:23], v89 offset:0
v_mfma_f32_32x32x16_bf16 v[176:191], v[48:51], v[96:99], 0
ds_read_b128 v[24:27], v90 offset:0
ds_read_b128 v[28:31], v91 offset:0
v_mfma_f32_32x32x16_bf16 v[176:191], v[52:55], v[100:103], v[176:191]
ds_read_b128 v[32:35], v92 offset:0
ds_read_b128 v[36:39], v93 offset:0
v_mfma_f32_32x32x16_bf16 v[176:191], v[56:59], v[104:107], v[176:191]
ds_read_b128 v[40:43], v94 offset:0
ds_read_b128 v[44:47], v95 offset:0
v_mfma_f32_32x32x16_bf16 v[176:191], v[60:63], v[108:111], v[176:191]
v_max3_f32 v15, v15, v160, v161
v_max3_f32 v15, v15, v162, v163
v_mfma_f32_32x32x16_bf16 v[176:191], v[64:67], v[112:115], v[176:191]
v_max3_f32 v15, v15, v164, v165
v_max3_f32 v15, v15, v166, v167
v_mfma_f32_32x32x16_bf16 v[176:191], v[68:71], v[116:119], v[176:191]
v_max3_f32 v15, v15, v168, v169
v_max3_f32 v15, v15, v170, v171
v_mfma_f32_32x32x16_bf16 v[176:191], v[72:75], v[120:123], v[176:191]
v_max3_f32 v15, v15, v172, v173
v_max3_f32 v15, v15, v174, v175
v_mfma_f32_32x32x16_bf16 v[176:191], v[76:79], v[124:127], v[176:191]
s_waitcnt lgkmcnt(0)
s_barrier
ds_read_b128 v[48:51], v88 offset:16384
ds_read_b128 v[52:55], v89 offset:16384
v_mfma_f32_32x32x16_bf16 v[192:207], v[16:19], v[96:99], 0
ds_read_b128 v[56:59], v90 offset:16384
ds_read_b128 v[60:63], v91 offset:16384
v_mfma_f32_32x32x16_bf16 v[192:207], v[20:23], v[100:103], v[192:207]
ds_read_b128 v[64:67], v92 offset:16384
ds_read_b128 v[68:71], v93 offset:16384
v_mfma_f32_32x32x16_bf16 v[192:207], v[24:27], v[104:107], v[192:207]
ds_read_b128 v[72:75], v94 offset:16384
ds_read_b128 v[76:79], v95 offset:16384
v_mfma_f32_32x32x16_bf16 v[192:207], v[28:31], v[108:111], v[192:207]
v_max3_f32 v15, v15, v176, v177
v_max3_f32 v15, v15, v178, v179
v_mfma_f32_32x32x16_bf16 v[192:207], v[32:35], v[112:115], v[192:207]
v_max3_f32 v15, v15, v180, v181
v_max3_f32 v15, v15, v182, v183
v_mfma_f32_32x32x16_bf16 v[192:207], v[36:39], v[116:119], v[192:207]
v_max3_f32 v15, v15, v184, v185
v_max3_f32 v15, v15, v186, v187
v_mfma_f32_32x32x16_bf16 v[192:207], v[40:43], v[120:123], v[192:207]
v_max3_f32 v15, v15, v188, v189
v_max3_f32 v15, v15, v190, v191
v_mfma_f32_32x32x16_bf16 v[192:207], v[44:47], v[124:127], v[192:207]
s_waitcnt lgkmcnt(0)
s_barrier
ds_read_b128 v[16:19], v88 offset:32768
ds_read_b128 v[20:23], v89 offset:32768
v_mfma_f32_32x32x16_bf16 v[208:223], v[48:51], v[96:99], 0
ds_read_b128 v[24:27], v90 offset:32768
ds_read_b128 v[28:31], v91 offset:32768
v_mfma_f32_32x32x16_bf16 v[208:223], v[52:55], v[100:103], v[208:223]
ds_read_b128 v[32:35], v92 offset:32768
ds_read_b128 v[36:39], v93 offset:32768
v_mfma_f32_32x32x16_bf16 v[208:223], v[56:59], v[104:107], v[208:223]
ds_read_b128 v[40:43], v94 offset:32768
ds_read_b128 v[44:47], v95 offset:32768
v_mfma_f32_32x32x16_bf16 v[208:223], v[60:63], v[108:111], v[208:223]
v_max3_f32 v15, v15, v192, v193
v_max3_f32 v15, v15, v194, v195
v_mfma_f32_32x32x16_bf16 v[208:223], v[64:67], v[112:115], v[208:223]
v_max3_f32 v15, v15, v196, v197
v_max3_f32 v15, v15, v198, v199
v_mfma_f32_32x32x16_bf16 v[208:223], v[68:71], v[116:119], v[208:223]
v_max3_f32 v15, v15, v200, v201
v_max3_f32 v15, v15, v202, v203
v_mfma_f32_32x32x16_bf16 v[208:223], v[72:75], v[120:123], v[208:223]
v_max3_f32 v15, v15, v204, v205
v_max3_f32 v15, v15, v206, v207
v_mfma_f32_32x32x16_bf16 v[208:223], v[76:79], v[124:127], v[208:223]
s_waitcnt lgkmcnt(0)
s_barrier
ds_read_b128 v[48:51], v88 offset:49152
ds_read_b128 v[52:55], v89 offset:49152
v_mfma_f32_32x32x16_bf16 v[224:239], v[16:19], v[96:99], 0
ds_read_b128 v[56:59], v90 offset:49152
ds_read_b128 v[60:63], v91 offset:49152
v_mfma_f32_32x32x16_bf16 v[224:239], v[20:23], v[100:103], v[224:239]
ds_read_b128 v[64:67], v92 offset:49152
ds_read_b128 v[68:71], v93 offset:49152
v_mfma_f32_32x32x16_bf16 v[224:239], v[24:27], v[104:107], v[224:239]
ds_read_b128 v[72:75], v94 offset:49152
ds_read_b128 v[76:79], v95 offset:49152
v_mfma_f32_32x32x16_bf16 v[224:239], v[28:31], v[108:111], v[224:239]
v_max3_f32 v15, v15, v208, v209
v_max3_f32 v15, v15, v210, v211
v_mfma_f32_32x32x16_bf16 v[224:239], v[32:35], v[112:115], v[224:239]
v_max3_f32 v15, v15, v212, v213
v_max3_f32 v15, v15, v214, v215
v_mfma_f32_32x32x16_bf16 v[224:239], v[36:39], v[116:119], v[224:239]
v_max3_f32 v15, v15, v216, v217
v_max3_f32 v15, v15, v218, v219
v_mfma_f32_32x32x16_bf16 v[224:239], v[40:43], v[120:123], v[224:239]
v_max3_f32 v15, v15, v220, v221
v_max3_f32 v15, v15, v222, v223
v_mfma_f32_32x32x16_bf16 v[224:239], v[44:47], v[124:127], v[224:239]
s_waitcnt lgkmcnt(0)
v_mfma_f32_32x32x16_bf16 v[240:255], v[48:51], v[96:99], 0
s_nop 9
v_max3_f32 v15, v15, v224, v225
v_mfma_f32_32x32x16_bf16 v[240:255], v[52:55], v[100:103], v[240:255]
v_max3_f32 v15, v15, v226, v227
v_max3_f32 v15, v15, v228, v229
v_mfma_f32_32x32x16_bf16 v[240:255], v[56:59], v[104:107], v[240:255]
v_max3_f32 v15, v15, v230, v231
v_max3_f32 v15, v15, v232, v233
v_mfma_f32_32x32x16_bf16 v[240:255], v[60:63], v[108:111], v[240:255]
v_max3_f32 v15, v15, v234, v235
v_max3_f32 v15, v15, v236, v237
v_mfma_f32_32x32x16_bf16 v[240:255], v[64:67], v[112:115], v[240:255]
v_max3_f32 v15, v15, v238, v239
v_mfma_f32_32x32x16_bf16 v[240:255], v[68:71], v[116:119], v[240:255]
v_mfma_f32_32x32x16_bf16 v[240:255], v[72:75], v[120:123], v[240:255]
v_mfma_f32_32x32x16_bf16 v[240:255], v[76:79], v[124:127], v[240:255]
s_nop 7
s_nop 3
v_max3_f32 v15, v15, v240, v241
v_max3_f32 v15, v15, v242, v243
v_max3_f32 v15, v15, v244, v245
v_max3_f32 v15, v15, v246, v247
v_max3_f32 v15, v15, v248, v249
v_max3_f32 v15, v15, v250, v251
v_max3_f32 v15, v15, v252, v253
v_max3_f32 v15, v15, v254, v255
s_branch K_kphase_done
K_kphase_b:
s_barrier
ds_read_b128 v[96:99], v12 offset:0
ds_read_b128 v[100:103], v12 offset:1024
ds_read_b128 v[104:107], v12 offset:2048
ds_read_b128 v[108:111], v12 offset:3072
ds_read_b128 v[112:115], v12 offset:8192
ds_read_b128 v[116:119], v12 offset:9216
ds_read_b128 v[120:123], v12 offset:10240
ds_read_b128 v[124:127], v12 offset:11264
ds_read_b128 v[16:19], v80 offset:0
ds_read_b128 v[20:23], v81 offset:0
ds_read_b128 v[24:27], v82 offset:0
ds_read_b128 v[28:31], v83 offset:0
s_waitcnt lgkmcnt(8)
ds_read_b128 v[32:35], v84 offset:0
ds_read_b128 v[36:39], v85 offset:0
ds_read_b128 v[40:43], v86 offset:0
ds_read_b128 v[44:47], v87 offset:0
s_waitcnt lgkmcnt(0)
s_barrier
ds_read_b128 v[48:51], v80 offset:16384
ds_read_b128 v[52:55], v81 offset:16384
v_mfma_f32_32x32x16_bf16 v[192:207], v[16:19], v[96:99], 0
ds_read_b128 v[56:59], v82 offset:16384
ds_read_b128 v[60:63], v83 offset:16384
v_mfma_f32_32x32x16_bf16 v[192:207], v[20:23], v[100:103], v[192:207]
ds_read_b128 v[64:67], v84 offset:16384
ds_read_b128 v[68:71], v85 offset:16384
v_mfma_f32_32x32x16_bf16 v[192:207], v[24:27], v[104:107], v[192:207]
ds_read_b128 v[72:75], v86 offset:16384
ds_read_b128 v[76:79], v87 offset:16384
v_mfma_f32_32x32x16_bf16 v[192:207], v[28:31], v[108:111], v[192:207]
v_mfma_f32_32x32x16_bf16 v[192:207], v[32:35], v[112:115], v[192:207]
v_mfma_f32_32x32x16_bf16 v[192:207], v[36:39], v[116:119], v[192:207]
v_mfma_f32_32x32x16_bf16 v[192:207], v[40:43], v[120:123], v[192:207]
v_mfma_f32_32x32x16_bf16 v[192:207], v[44:47], v[124:127], v[192:207]
s_waitcnt lgkmcnt(0)
s_barrier
ds_read_b128 v[16:19], v80 offset:32768
ds_read_b128 v[20:23], v81 offset:32768
v_mfma_f32_32x32x16_bf16 v[208:223], v[48:51], v[96:99], 0
ds_read_b128 v[24:27], v82 offset:32768
ds_read_b128 v[28:31], v83 offset:32768
v_mfma_f32_32x32x16_bf16 v[208:223], v[52:55], v[100:103], v[208:223]
ds_read_b128 v[32:35], v84 offset:32768
ds_read_b128 v[36:39], v85 offset:32768
v_mfma_f32_32x32x16_bf16 v[208:223], v[56:59], v[104:107], v[208:223]
ds_read_b128 v[40:43], v86 offset:32768
ds_read_b128 v[44:47], v87 offset:32768
v_mfma_f32_32x32x16_bf16 v[208:223], v[60:63], v[108:111], v[208:223]
v_max_f32 v15, v192, v193
v_max3_f32 v15, v15, v194, v195
v_mfma_f32_32x32x16_bf16 v[208:223], v[64:67], v[112:115], v[208:223]
v_max3_f32 v15, v15, v196, v197
v_max3_f32 v15, v15, v198, v199
v_mfma_f32_32x32x16_bf16 v[208:223], v[68:71], v[116:119], v[208:223]
v_max3_f32 v15, v15, v200, v201
v_max3_f32 v15, v15, v202, v203
v_mfma_f32_32x32x16_bf16 v[208:223], v[72:75], v[120:123], v[208:223]
v_max3_f32 v15, v15, v204, v205
v_max3_f32 v15, v15, v206, v207
v_mfma_f32_32x32x16_bf16 v[208:223], v[76:79], v[124:127], v[208:223]
s_waitcnt lgkmcnt(0)
s_barrier
ds_read_b128 v[48:51], v80 offset:49152
ds_read_b128 v[52:55], v81 offset:49152
v_mfma_f32_32x32x16_bf16 v[224:239], v[16:19], v[96:99], 0
ds_read_b128 v[56:59], v82 offset:49152
ds_read_b128 v[60:63], v83 offset:49152
v_mfma_f32_32x32x16_bf16 v[224:239], v[20:23], v[100:103], v[224:239]
ds_read_b128 v[64:67], v84 offset:49152
ds_read_b128 v[68:71], v85 offset:49152
v_mfma_f32_32x32x16_bf16 v[224:239], v[24:27], v[104:107], v[224:239]
ds_read_b128 v[72:75], v86 offset:49152
ds_read_b128 v[76:79], v87 offset:49152
v_mfma_f32_32x32x16_bf16 v[224:239], v[28:31], v[108:111], v[224:239]
v_max3_f32 v15, v15, v208, v209
v_max3_f32 v15, v15, v210, v211
v_mfma_f32_32x32x16_bf16 v[224:239], v[32:35], v[112:115], v[224:239]
v_max3_f32 v15, v15, v212, v213
v_max3_f32 v15, v15, v214, v215
v_mfma_f32_32x32x16_bf16 v[224:239], v[36:39], v[116:119], v[224:239]
v_max3_f32 v15, v15, v216, v217
v_max3_f32 v15, v15, v218, v219
v_mfma_f32_32x32x16_bf16 v[224:239], v[40:43], v[120:123], v[224:239]
v_max3_f32 v15, v15, v220, v221
v_max3_f32 v15, v15, v222, v223
v_mfma_f32_32x32x16_bf16 v[224:239], v[44:47], v[124:127], v[224:239]
s_waitcnt lgkmcnt(0)
s_barrier
ds_read_b128 v[16:19], v88 offset:0
ds_read_b128 v[20:23], v89 offset:0
v_mfma_f32_32x32x16_bf16 v[240:255], v[48:51], v[96:99], 0
ds_read_b128 v[24:27], v90 offset:0
ds_read_b128 v[28:31], v91 offset:0
v_mfma_f32_32x32x16_bf16 v[240:255], v[52:55], v[100:103], v[240:255]
ds_read_b128 v[32:35], v92 offset:0
ds_read_b128 v[36:39], v93 offset:0
v_mfma_f32_32x32x16_bf16 v[240:255], v[56:59], v[104:107], v[240:255]
ds_read_b128 v[40:43], v94 offset:0
ds_read_b128 v[44:47], v95 offset:0
v_mfma_f32_32x32x16_bf16 v[240:255], v[60:63], v[108:111], v[240:255]
v_max3_f32 v15, v15, v224, v225
v_max3_f32 v15, v15, v226, v227
v_mfma_f32_32x32x16_bf16 v[240:255], v[64:67], v[112:115], v[240:255]
v_max3_f32 v15, v15, v228, v229
v_max3_f32 v15, v15, v230, v231
v_mfma_f32_32x32x16_bf16 v[240:255], v[68:71], v[116:119], v[240:255]
v_max3_f32 v15, v15, v232, v233
v_max3_f32 v15, v15, v234, v235
v_mfma_f32_32x32x16_bf16 v[240:255], v[72:75], v[120:123], v[240:255]
v_max3_f32 v15, v15, v236, v237
v_max3_f32 v15, v15, v238, v239
v_mfma_f32_32x32x16_bf16 v[240:255], v[76:79], v[124:127], v[240:255]
s_waitcnt lgkmcnt(0)
s_barrier
ds_read_b128 v[48:51], v88 offset:16384
ds_read_b128 v[52:55], v89 offset:16384
v_mfma_f32_32x32x16_bf16 v[128:143], v[16:19], v[96:99], 0
ds_read_b128 v[56:59], v90 offset:16384
ds_read_b128 v[60:63], v91 offset:16384
v_mfma_f32_32x32x16_bf16 v[128:143], v[20:23], v[100:103], v[128:143]
ds_read_b128 v[64:67], v92 offset:16384
ds_read_b128 v[68:71], v93 offset:16384
v_mfma_f32_32x32x16_bf16 v[128:143], v[24:27], v[104:107], v[128:143]
ds_read_b128 v[72:75], v94 offset:16384
ds_read_b128 v[76:79], v95 offset:16384
v_mfma_f32_32x32x16_bf16 v[128:143], v[28:31], v[108:111], v[128:143]
v_max3_f32 v15, v15, v240, v241
v_max3_f32 v15, v15, v242, v243
v_mfma_f32_32x32x16_bf16 v[128:143], v[32:35], v[112:115], v[128:143]
v_max3_f32 v15, v15, v244, v245
v_max3_f32 v15, v15, v246, v247
v_mfma_f32_32x32x16_bf16 v[128:143], v[36:39], v[116:119], v[128:143]
v_max3_f32 v15, v15, v248, v249
v_max3_f32 v15, v15, v250, v251
v_mfma_f32_32x32x16_bf16 v[128:143], v[40:43], v[120:123], v[128:143]
v_max3_f32 v15, v15, v252, v253
v_max3_f32 v15, v15, v254, v255
v_mfma_f32_32x32x16_bf16 v[128:143], v[44:47], v[124:127], v[128:143]
s_waitcnt lgkmcnt(0)
s_barrier
ds_read_b128 v[16:19], v88 offset:32768
ds_read_b128 v[20:23], v89 offset:32768
v_mfma_f32_32x32x16_bf16 v[144:159], v[48:51], v[96:99], 0
ds_read_b128 v[24:27], v90 offset:32768
ds_read_b128 v[28:31], v91 offset:32768
v_mfma_f32_32x32x16_bf16 v[144:159], v[52:55], v[100:103], v[144:159]
ds_read_b128 v[32:35], v92 offset:32768
ds_read_b128 v[36:39], v93 offset:32768
v_mfma_f32_32x32x16_bf16 v[144:159], v[56:59], v[104:107], v[144:159]
ds_read_b128 v[40:43], v94 offset:32768
ds_read_b128 v[44:47], v95 offset:32768
v_mfma_f32_32x32x16_bf16 v[144:159], v[60:63], v[108:111], v[144:159]
v_max3_f32 v15, v15, v128, v129
v_max3_f32 v15, v15, v130, v131
v_mfma_f32_32x32x16_bf16 v[144:159], v[64:67], v[112:115], v[144:159]
v_max3_f32 v15, v15, v132, v133
v_max3_f32 v15, v15, v134, v135
v_mfma_f32_32x32x16_bf16 v[144:159], v[68:71], v[116:119], v[144:159]
v_max3_f32 v15, v15, v136, v137
v_max3_f32 v15, v15, v138, v139
v_mfma_f32_32x32x16_bf16 v[144:159], v[72:75], v[120:123], v[144:159]
v_max3_f32 v15, v15, v140, v141
v_max3_f32 v15, v15, v142, v143
v_mfma_f32_32x32x16_bf16 v[144:159], v[76:79], v[124:127], v[144:159]
s_waitcnt lgkmcnt(0)
s_barrier
ds_read_b128 v[48:51], v88 offset:49152
ds_read_b128 v[52:55], v89 offset:49152
v_mfma_f32_32x32x16_bf16 v[160:175], v[16:19], v[96:99], 0
ds_read_b128 v[56:59], v90 offset:49152
ds_read_b128 v[60:63], v91 offset:49152
v_mfma_f32_32x32x16_bf16 v[160:175], v[20:23], v[100:103], v[160:175]
ds_read_b128 v[64:67], v92 offset:49152
ds_read_b128 v[68:71], v93 offset:49152
v_mfma_f32_32x32x16_bf16 v[160:175], v[24:27], v[104:107], v[160:175]
ds_read_b128 v[72:75], v94 offset:49152
ds_read_b128 v[76:79], v95 offset:49152
v_mfma_f32_32x32x16_bf16 v[160:175], v[28:31], v[108:111], v[160:175]
v_max3_f32 v15, v15, v144, v145
v_max3_f32 v15, v15, v146, v147
v_mfma_f32_32x32x16_bf16 v[160:175], v[32:35], v[112:115], v[160:175]
v_max3_f32 v15, v15, v148, v149
v_max3_f32 v15, v15, v150, v151
v_mfma_f32_32x32x16_bf16 v[160:175], v[36:39], v[116:119], v[160:175]
v_max3_f32 v15, v15, v152, v153
v_max3_f32 v15, v15, v154, v155
v_mfma_f32_32x32x16_bf16 v[160:175], v[40:43], v[120:123], v[160:175]
v_max3_f32 v15, v15, v156, v157
v_max3_f32 v15, v15, v158, v159
v_mfma_f32_32x32x16_bf16 v[160:175], v[44:47], v[124:127], v[160:175]
s_waitcnt lgkmcnt(0)
v_mfma_f32_32x32x16_bf16 v[176:191], v[48:51], v[96:99], 0
s_nop 9
v_max3_f32 v15, v15, v160, v161
v_mfma_f32_32x32x16_bf16 v[176:191], v[52:55], v[100:103], v[176:191]
v_max3_f32 v15, v15, v162, v163
v_max3_f32 v15, v15, v164, v165
v_mfma_f32_32x32x16_bf16 v[176:191], v[56:59], v[104:107], v[176:191]
v_max3_f32 v15, v15, v166, v167
v_max3_f32 v15, v15, v168, v169
v_mfma_f32_32x32x16_bf16 v[176:191], v[60:63], v[108:111], v[176:191]
v_max3_f32 v15, v15, v170, v171
v_max3_f32 v15, v15, v172, v173
v_mfma_f32_32x32x16_bf16 v[176:191], v[64:67], v[112:115], v[176:191]
v_max3_f32 v15, v15, v174, v175
v_mfma_f32_32x32x16_bf16 v[176:191], v[68:71], v[116:119], v[176:191]
v_mfma_f32_32x32x16_bf16 v[176:191], v[72:75], v[120:123], v[176:191]
v_mfma_f32_32x32x16_bf16 v[176:191], v[76:79], v[124:127], v[176:191]
s_nop 7
s_nop 3
v_max3_f32 v15, v15, v176, v177
v_max3_f32 v15, v15, v178, v179
v_max3_f32 v15, v15, v180, v181
v_max3_f32 v15, v15, v182, v183
v_max3_f32 v15, v15, v184, v185
v_max3_f32 v15, v15, v186, v187
v_max3_f32 v15, v15, v188, v189
v_max3_f32 v15, v15, v190, v191
K_kphase_done:
v_lshrrev_b32 v66, 1, v5
v_lshl_add_u32 v66, v66, 2, v7
s_lshl_b32 s28, s47, 5
v_add_u32 v66, s28, v66
v_lshlrev_b32 v66, 8, v66
v_and_b32 v67, 1, v5
v_lshl_add_u32 v66, v67, 5, v66
v_lshl_add_u32 v66, v8, 3, v66
s_lshl_b32 s28, s47, 1
v_xor_b32 v67, s28, v7

v_xor_b32 v68, 0, v67
v_lshl_add_u32 v3, v68, 6, v66
v_xor_b32 v68, 1, v67
v_lshl_add_u32 v4, v68, 6, v66
v_xor_b32 v68, 2, v67
v_lshl_add_u32 v5, v68, 6, v66
v_xor_b32 v68, 3, v67
v_lshl_add_u32 v6, v68, 6, v66
v_lshlrev_b32 v9, 2, v2
s_lshl_b32 s28, s16, 8
v_add_u32 v13, s28, v9
v_add_u32 v13, 155648, v13
s_xor_b32 s28, s16, 2
s_lshl_b32 s28, s28, 8
v_add_u32 v14, s28, v9
v_add_u32 v14, 155648, v14
v_mov_b32 v8, 0x3f803f80
v_mov_b32 v9, 0x3f803f80
v_mov_b32 v10, 0x3f803f80
v_mov_b32 v11, 0x3f803f80
s_mov_b32 s40, 0x3e0293ee

v_mov_b32 v12, v15
s_nop 1
v_permlane32_swap_b32 v15, v12
s_nop 1
v_max_f32 v7, v15, v12
ds_write_b32 v13, v7
s_waitcnt lgkmcnt(0)

s_barrier
v_mov_b32 v13, 156672
ds_read_b32 v12, v14
ds_read_b32 v13, v13
s_waitcnt lgkmcnt(0)
v_readfirstlane_b32 s50, v13
v_max_f32 v7, v7, v12

v_mul_f32 v7, s40, v7
v_sub_f32 v7, 0, v7
v_add_u32 v12, 65536, v3
v_add_u32 v13, 65536, v4
v_add_u32 v14, 65536, v5
v_add_u32 v15, 65536, v6
v_lshlrev_b32 v1, 2, v2
v_and_b32 v1, 12, v1
buffer_load_dword v1, v1, s[20:23], s51 offen sc1
v_mov_b32 v0, v7
ds_read_b64_tr_b16 v[96:97], v3 offset:0
ds_read_b64_tr_b16 v[98:99], v3 offset:2048
ds_read_b64_tr_b16 v[100:101], v4 offset:0
ds_read_b64_tr_b16 v[102:103], v4 offset:2048
ds_read_b64_tr_b16 v[104:105], v5 offset:0
ds_read_b64_tr_b16 v[106:107], v5 offset:2048
ds_read_b64_tr_b16 v[108:109], v6 offset:0
ds_read_b64_tr_b16 v[110:111], v6 offset:2048
v_fma_f32 v128, v128, s40, v7
v_fma_f32 v129, v129, s40, v7
v_fma_f32 v130, v130, s40, v7
v_fma_f32 v131, v131, s40, v7
v_fma_f32 v132, v132, s40, v7
v_fma_f32 v133, v133, s40, v7
v_fma_f32 v134, v134, s40, v7
v_fma_f32 v135, v135, s40, v7
v_exp_f32 v128, v128
v_exp_f32 v129, v129
v_exp_f32 v130, v130
v_exp_f32 v131, v131
v_exp_f32 v132, v132
v_exp_f32 v133, v133
v_exp_f32 v134, v134
v_exp_f32 v135, v135
v_cvt_pk_bf16_f32 v128, v128, v129
v_cvt_pk_bf16_f32 v129, v130, v131
v_cvt_pk_bf16_f32 v130, v132, v133
v_cvt_pk_bf16_f32 v131, v134, v135
v_fma_f32 v136, v136, s40, v7
v_fma_f32 v137, v137, s40, v7
v_fma_f32 v138, v138, s40, v7
v_fma_f32 v139, v139, s40, v7
v_fma_f32 v140, v140, s40, v7
v_fma_f32 v141, v141, s40, v7
v_fma_f32 v142, v142, s40, v7
v_fma_f32 v143, v143, s40, v7
v_exp_f32 v136, v136
v_exp_f32 v137, v137
v_exp_f32 v138, v138
v_exp_f32 v139, v139
v_exp_f32 v140, v140
v_exp_f32 v141, v141
v_exp_f32 v142, v142
v_exp_f32 v143, v143
v_cvt_pk_bf16_f32 v136, v136, v137
v_cvt_pk_bf16_f32 v137, v138, v139
v_cvt_pk_bf16_f32 v138, v140, v141
v_cvt_pk_bf16_f32 v139, v142, v143
s_waitcnt lgkmcnt(4)
ds_read_b64_tr_b16 v[112:113], v3 offset:4096
ds_read_b64_tr_b16 v[114:115], v3 offset:6144
ds_read_b64_tr_b16 v[116:117], v4 offset:4096
ds_read_b64_tr_b16 v[118:119], v4 offset:6144
ds_read_b64_tr_b16 v[120:121], v5 offset:4096
ds_read_b64_tr_b16 v[122:123], v5 offset:6144
ds_read_b64_tr_b16 v[124:125], v6 offset:4096
ds_read_b64_tr_b16 v[126:127], v6 offset:6144
s_waitcnt lgkmcnt(8)
v_mfma_f32_32x32x16_bf16 v[16:31], v[96:99], v[128:131], 0
v_fma_f32 v144, v144, s40, v7
v_fma_f32 v145, v145, s40, v7
v_fma_f32 v146, v146, s40, v7
v_fma_f32 v147, v147, s40, v7
v_mfma_f32_32x32x16_bf16 v[32:47], v[100:103], v[128:131], 0
v_fma_f32 v148, v148, s40, v7
v_fma_f32 v149, v149, s40, v7
v_fma_f32 v150, v150, s40, v7
v_fma_f32 v151, v151, s40, v7
v_mfma_f32_32x32x16_bf16 v[48:63], v[104:107], v[128:131], 0
v_exp_f32 v144, v144
v_exp_f32 v145, v145
v_exp_f32 v146, v146
v_exp_f32 v147, v147
v_mfma_f32_32x32x16_bf16 v[64:79], v[108:111], v[128:131], 0
v_exp_f32 v148, v148
v_exp_f32 v149, v149
v_exp_f32 v150, v150
v_exp_f32 v151, v151
v_mfma_f32_32x32x16_bf16 v[80:95], v[8:11], v[128:131], 0
v_cvt_pk_bf16_f32 v144, v144, v145
v_cvt_pk_bf16_f32 v145, v146, v147
v_cvt_pk_bf16_f32 v146, v148, v149
v_cvt_pk_bf16_f32 v147, v150, v151
s_waitcnt lgkmcnt(0)
s_barrier
ds_read_b64_tr_b16 v[96:97], v3 offset:16384
ds_read_b64_tr_b16 v[98:99], v3 offset:18432
ds_read_b64_tr_b16 v[100:101], v4 offset:16384
ds_read_b64_tr_b16 v[102:103], v4 offset:18432
v_mfma_f32_32x32x16_bf16 v[16:31], v[112:115], v[136:139], v[16:31]
ds_read_b64_tr_b16 v[104:105], v5 offset:16384
ds_read_b64_tr_b16 v[106:107], v5 offset:18432
ds_read_b64_tr_b16 v[108:109], v6 offset:16384
ds_read_b64_tr_b16 v[110:111], v6 offset:18432
v_fma_f32 v152, v152, s40, v7
v_mfma_f32_32x32x16_bf16 v[32:47], v[116:119], v[136:139], v[32:47]
v_fma_f32 v153, v153, s40, v7
v_fma_f32 v154, v154, s40, v7
v_fma_f32 v155, v155, s40, v7
v_fma_f32 v156, v156, s40, v7
v_fma_f32 v157, v157, s40, v7
v_mfma_f32_32x32x16_bf16 v[48:63], v[120:123], v[136:139], v[48:63]
v_fma_f32 v158, v158, s40, v7
v_fma_f32 v159, v159, s40, v7
v_exp_f32 v152, v152
v_exp_f32 v153, v153
v_exp_f32 v154, v154
v_mfma_f32_32x32x16_bf16 v[64:79], v[124:127], v[136:139], v[64:79]
v_exp_f32 v155, v155
v_exp_f32 v156, v156
v_exp_f32 v157, v157
v_exp_f32 v158, v158
v_exp_f32 v159, v159
v_mfma_f32_32x32x16_bf16 v[80:95], v[8:11], v[136:139], v[80:95]
v_cvt_pk_bf16_f32 v152, v152, v153
v_cvt_pk_bf16_f32 v153, v154, v155
v_cvt_pk_bf16_f32 v154, v156, v157
v_cvt_pk_bf16_f32 v155, v158, v159
ds_read_b64_tr_b16 v[112:113], v3 offset:20480
ds_read_b64_tr_b16 v[114:115], v3 offset:22528
ds_read_b64_tr_b16 v[116:117], v4 offset:20480
ds_read_b64_tr_b16 v[118:119], v4 offset:22528
s_waitcnt lgkmcnt(4)
v_mfma_f32_32x32x16_bf16 v[16:31], v[96:99], v[144:147], v[16:31]
ds_read_b64_tr_b16 v[120:121], v5 offset:20480
ds_read_b64_tr_b16 v[122:123], v5 offset:22528
ds_read_b64_tr_b16 v[124:125], v6 offset:20480
ds_read_b64_tr_b16 v[126:127], v6 offset:22528
v_fma_f32 v160, v160, s40, v7
v_mfma_f32_32x32x16_bf16 v[32:47], v[100:103], v[144:147], v[32:47]
v_fma_f32 v161, v161, s40, v7
v_fma_f32 v162, v162, s40, v7
v_fma_f32 v163, v163, s40, v7
v_fma_f32 v164, v164, s40, v7
v_fma_f32 v165, v165, s40, v7
v_mfma_f32_32x32x16_bf16 v[48:63], v[104:107], v[144:147], v[48:63]
v_fma_f32 v166, v166, s40, v7
v_fma_f32 v167, v167, s40, v7
v_exp_f32 v160, v160
v_exp_f32 v161, v161
v_exp_f32 v162, v162
v_mfma_f32_32x32x16_bf16 v[64:79], v[108:111], v[144:147], v[64:79]
v_exp_f32 v163, v163
v_exp_f32 v164, v164
v_exp_f32 v165, v165
v_exp_f32 v166, v166
v_exp_f32 v167, v167
v_mfma_f32_32x32x16_bf16 v[80:95], v[8:11], v[144:147], v[80:95]
v_cvt_pk_bf16_f32 v160, v160, v161
v_cvt_pk_bf16_f32 v161, v162, v163
v_cvt_pk_bf16_f32 v162, v164, v165
v_cvt_pk_bf16_f32 v163, v166, v167
s_waitcnt lgkmcnt(0)
s_barrier
ds_read_b64_tr_b16 v[96:97], v3 offset:32768
ds_read_b64_tr_b16 v[98:99], v3 offset:34816
ds_read_b64_tr_b16 v[100:101], v4 offset:32768
ds_read_b64_tr_b16 v[102:103], v4 offset:34816
v_mfma_f32_32x32x16_bf16 v[16:31], v[112:115], v[152:155], v[16:31]
ds_read_b64_tr_b16 v[104:105], v5 offset:32768
ds_read_b64_tr_b16 v[106:107], v5 offset:34816
ds_read_b64_tr_b16 v[108:109], v6 offset:32768
ds_read_b64_tr_b16 v[110:111], v6 offset:34816
v_fma_f32 v168, v168, s40, v7
v_mfma_f32_32x32x16_bf16 v[32:47], v[116:119], v[152:155], v[32:47]
v_fma_f32 v169, v169, s40, v7
v_fma_f32 v170, v170, s40, v7
v_fma_f32 v171, v171, s40, v7
v_fma_f32 v172, v172, s40, v7
v_fma_f32 v173, v173, s40, v7
v_mfma_f32_32x32x16_bf16 v[48:63], v[120:123], v[152:155], v[48:63]
v_fma_f32 v174, v174, s40, v7
v_fma_f32 v175, v175, s40, v7
v_exp_f32 v168, v168
v_exp_f32 v169, v169
v_exp_f32 v170, v170
v_mfma_f32_32x32x16_bf16 v[64:79], v[124:127], v[152:155], v[64:79]
v_exp_f32 v171, v171
v_exp_f32 v172, v172
v_exp_f32 v173, v173
v_exp_f32 v174, v174
v_exp_f32 v175, v175
v_mfma_f32_32x32x16_bf16 v[80:95], v[8:11], v[152:155], v[80:95]
v_cvt_pk_bf16_f32 v168, v168, v169
v_cvt_pk_bf16_f32 v169, v170, v171
v_cvt_pk_bf16_f32 v170, v172, v173
v_cvt_pk_bf16_f32 v171, v174, v175
ds_read_b64_tr_b16 v[112:113], v3 offset:36864
ds_read_b64_tr_b16 v[114:115], v3 offset:38912
ds_read_b64_tr_b16 v[116:117], v4 offset:36864
ds_read_b64_tr_b16 v[118:119], v4 offset:38912
s_waitcnt lgkmcnt(4)
v_mfma_f32_32x32x16_bf16 v[16:31], v[96:99], v[160:163], v[16:31]
ds_read_b64_tr_b16 v[120:121], v5 offset:36864
ds_read_b64_tr_b16 v[122:123], v5 offset:38912
ds_read_b64_tr_b16 v[124:125], v6 offset:36864
ds_read_b64_tr_b16 v[126:127], v6 offset:38912
v_fma_f32 v176, v176, s40, v7
v_mfma_f32_32x32x16_bf16 v[32:47], v[100:103], v[160:163], v[32:47]
v_fma_f32 v177, v177, s40, v7
v_fma_f32 v178, v178, s40, v7
v_fma_f32 v179, v179, s40, v7
v_fma_f32 v180, v180, s40, v7
v_fma_f32 v181, v181, s40, v7
v_mfma_f32_32x32x16_bf16 v[48:63], v[104:107], v[160:163], v[48:63]
v_fma_f32 v182, v182, s40, v7
v_fma_f32 v183, v183, s40, v7
v_exp_f32 v176, v176
v_exp_f32 v177, v177
v_exp_f32 v178, v178
v_mfma_f32_32x32x16_bf16 v[64:79], v[108:111], v[160:163], v[64:79]
v_exp_f32 v179, v179
v_exp_f32 v180, v180
v_exp_f32 v181, v181
v_exp_f32 v182, v182
v_exp_f32 v183, v183
v_mfma_f32_32x32x16_bf16 v[80:95], v[8:11], v[160:163], v[80:95]
v_cvt_pk_bf16_f32 v176, v176, v177
v_cvt_pk_bf16_f32 v177, v178, v179
v_cvt_pk_bf16_f32 v178, v180, v181
v_cvt_pk_bf16_f32 v179, v182, v183
s_waitcnt lgkmcnt(0)
s_barrier
ds_read_b64_tr_b16 v[96:97], v3 offset:49152
ds_read_b64_tr_b16 v[98:99], v3 offset:51200
ds_read_b64_tr_b16 v[100:101], v4 offset:49152
ds_read_b64_tr_b16 v[102:103], v4 offset:51200
v_mfma_f32_32x32x16_bf16 v[16:31], v[112:115], v[168:171], v[16:31]
ds_read_b64_tr_b16 v[104:105], v5 offset:49152
ds_read_b64_tr_b16 v[106:107], v5 offset:51200
ds_read_b64_tr_b16 v[108:109], v6 offset:49152
ds_read_b64_tr_b16 v[110:111], v6 offset:51200
v_fma_f32 v184, v184, s40, v7
v_mfma_f32_32x32x16_bf16 v[32:47], v[116:119], v[168:171], v[32:47]
v_fma_f32 v185, v185, s40, v7
v_fma_f32 v186, v186, s40, v7
v_fma_f32 v187, v187, s40, v7
v_fma_f32 v188, v188, s40, v7
v_fma_f32 v189, v189, s40, v7
v_mfma_f32_32x32x16_bf16 v[48:63], v[120:123], v[168:171], v[48:63]
v_fma_f32 v190, v190, s40, v7
v_fma_f32 v191, v191, s40, v7
v_exp_f32 v184, v184
v_exp_f32 v185, v185
v_exp_f32 v186, v186
v_mfma_f32_32x32x16_bf16 v[64:79], v[124:127], v[168:171], v[64:79]
v_exp_f32 v187, v187
v_exp_f32 v188, v188
v_exp_f32 v189, v189
v_exp_f32 v190, v190
v_exp_f32 v191, v191
v_mfma_f32_32x32x16_bf16 v[80:95], v[8:11], v[168:171], v[80:95]
v_cvt_pk_bf16_f32 v184, v184, v185
v_cvt_pk_bf16_f32 v185, v186, v187
v_cvt_pk_bf16_f32 v186, v188, v189
v_cvt_pk_bf16_f32 v187, v190, v191
ds_read_b64_tr_b16 v[112:113], v3 offset:53248
ds_read_b64_tr_b16 v[114:115], v3 offset:55296
ds_read_b64_tr_b16 v[116:117], v4 offset:53248
ds_read_b64_tr_b16 v[118:119], v4 offset:55296
s_waitcnt lgkmcnt(4)
v_mfma_f32_32x32x16_bf16 v[16:31], v[96:99], v[176:179], v[16:31]
ds_read_b64_tr_b16 v[120:121], v5 offset:53248
ds_read_b64_tr_b16 v[122:123], v5 offset:55296
ds_read_b64_tr_b16 v[124:125], v6 offset:53248
ds_read_b64_tr_b16 v[126:127], v6 offset:55296
v_fma_f32 v192, v192, s40, v7
v_mfma_f32_32x32x16_bf16 v[32:47], v[100:103], v[176:179], v[32:47]
v_fma_f32 v193, v193, s40, v7
v_fma_f32 v194, v194, s40, v7
v_fma_f32 v195, v195, s40, v7
v_fma_f32 v196, v196, s40, v7
v_fma_f32 v197, v197, s40, v7
v_mfma_f32_32x32x16_bf16 v[48:63], v[104:107], v[176:179], v[48:63]
v_fma_f32 v198, v198, s40, v7
v_fma_f32 v199, v199, s40, v7
v_exp_f32 v192, v192
v_exp_f32 v193, v193
v_exp_f32 v194, v194
v_mfma_f32_32x32x16_bf16 v[64:79], v[108:111], v[176:179], v[64:79]
v_exp_f32 v195, v195
v_exp_f32 v196, v196
v_exp_f32 v197, v197
v_exp_f32 v198, v198
v_exp_f32 v199, v199
v_mfma_f32_32x32x16_bf16 v[80:95], v[8:11], v[176:179], v[80:95]
v_cvt_pk_bf16_f32 v192, v192, v193
v_cvt_pk_bf16_f32 v193, v194, v195
v_cvt_pk_bf16_f32 v194, v196, v197
v_cvt_pk_bf16_f32 v195, v198, v199
s_waitcnt lgkmcnt(0)
s_barrier
ds_read_b64_tr_b16 v[96:97], v12 offset:0
ds_read_b64_tr_b16 v[98:99], v12 offset:2048
ds_read_b64_tr_b16 v[100:101], v13 offset:0
ds_read_b64_tr_b16 v[102:103], v13 offset:2048
v_mfma_f32_32x32x16_bf16 v[16:31], v[112:115], v[184:187], v[16:31]
ds_read_b64_tr_b16 v[104:105], v14 offset:0
ds_read_b64_tr_b16 v[106:107], v14 offset:2048
ds_read_b64_tr_b16 v[108:109], v15 offset:0
ds_read_b64_tr_b16 v[110:111], v15 offset:2048
v_fma_f32 v200, v200, s40, v7
v_mfma_f32_32x32x16_bf16 v[32:47], v[116:119], v[184:187], v[32:47]
v_fma_f32 v201, v201, s40, v7
v_fma_f32 v202, v202, s40, v7
v_fma_f32 v203, v203, s40, v7
v_fma_f32 v204, v204, s40, v7
v_fma_f32 v205, v205, s40, v7
v_mfma_f32_32x32x16_bf16 v[48:63], v[120:123], v[184:187], v[48:63]
v_fma_f32 v206, v206, s40, v7
v_fma_f32 v207, v207, s40, v7
v_exp_f32 v200, v200
v_exp_f32 v201, v201
v_exp_f32 v202, v202
v_mfma_f32_32x32x16_bf16 v[64:79], v[124:127], v[184:187], v[64:79]
v_exp_f32 v203, v203
v_exp_f32 v204, v204
v_exp_f32 v205, v205
v_exp_f32 v206, v206
v_exp_f32 v207, v207
v_mfma_f32_32x32x16_bf16 v[80:95], v[8:11], v[184:187], v[80:95]
v_cvt_pk_bf16_f32 v200, v200, v201
v_cvt_pk_bf16_f32 v201, v202, v203
v_cvt_pk_bf16_f32 v202, v204, v205
v_cvt_pk_bf16_f32 v203, v206, v207
ds_read_b64_tr_b16 v[112:113], v12 offset:4096
ds_read_b64_tr_b16 v[114:115], v12 offset:6144
ds_read_b64_tr_b16 v[116:117], v13 offset:4096
ds_read_b64_tr_b16 v[118:119], v13 offset:6144
s_waitcnt lgkmcnt(4)
v_mfma_f32_32x32x16_bf16 v[16:31], v[96:99], v[192:195], v[16:31]
ds_read_b64_tr_b16 v[120:121], v14 offset:4096
ds_read_b64_tr_b16 v[122:123], v14 offset:6144
ds_read_b64_tr_b16 v[124:125], v15 offset:4096
ds_read_b64_tr_b16 v[126:127], v15 offset:6144
v_fma_f32 v208, v208, s40, v7
v_mfma_f32_32x32x16_bf16 v[32:47], v[100:103], v[192:195], v[32:47]
v_fma_f32 v209, v209, s40, v7
v_fma_f32 v210, v210, s40, v7
v_fma_f32 v211, v211, s40, v7
v_fma_f32 v212, v212, s40, v7
v_fma_f32 v213, v213, s40, v7
v_mfma_f32_32x32x16_bf16 v[48:63], v[104:107], v[192:195], v[48:63]
v_fma_f32 v214, v214, s40, v7
v_fma_f32 v215, v215, s40, v7
v_exp_f32 v208, v208
v_exp_f32 v209, v209
v_exp_f32 v210, v210
v_mfma_f32_32x32x16_bf16 v[64:79], v[108:111], v[192:195], v[64:79]
v_exp_f32 v211, v211
v_exp_f32 v212, v212
v_exp_f32 v213, v213
v_exp_f32 v214, v214
v_exp_f32 v215, v215
v_mfma_f32_32x32x16_bf16 v[80:95], v[8:11], v[192:195], v[80:95]
v_cvt_pk_bf16_f32 v208, v208, v209
v_cvt_pk_bf16_f32 v209, v210, v211
v_cvt_pk_bf16_f32 v210, v212, v213
v_cvt_pk_bf16_f32 v211, v214, v215
s_waitcnt lgkmcnt(0)
s_barrier
ds_read_b64_tr_b16 v[96:97], v12 offset:16384
ds_read_b64_tr_b16 v[98:99], v12 offset:18432
ds_read_b64_tr_b16 v[100:101], v13 offset:16384
ds_read_b64_tr_b16 v[102:103], v13 offset:18432
v_mfma_f32_32x32x16_bf16 v[16:31], v[112:115], v[200:203], v[16:31]
ds_read_b64_tr_b16 v[104:105], v14 offset:16384
ds_read_b64_tr_b16 v[106:107], v14 offset:18432
ds_read_b64_tr_b16 v[108:109], v15 offset:16384
ds_read_b64_tr_b16 v[110:111], v15 offset:18432
v_fma_f32 v216, v216, s40, v7
v_mfma_f32_32x32x16_bf16 v[32:47], v[116:119], v[200:203], v[32:47]
v_fma_f32 v217, v217, s40, v7
v_fma_f32 v218, v218, s40, v7
v_fma_f32 v219, v219, s40, v7
v_fma_f32 v220, v220, s40, v7
v_fma_f32 v221, v221, s40, v7
v_mfma_f32_32x32x16_bf16 v[48:63], v[120:123], v[200:203], v[48:63]
v_fma_f32 v222, v222, s40, v7
v_fma_f32 v223, v223, s40, v7
v_exp_f32 v216, v216
v_exp_f32 v217, v217
v_exp_f32 v218, v218
v_mfma_f32_32x32x16_bf16 v[64:79], v[124:127], v[200:203], v[64:79]
v_exp_f32 v219, v219
v_exp_f32 v220, v220
v_exp_f32 v221, v221
v_exp_f32 v222, v222
v_exp_f32 v223, v223
v_mfma_f32_32x32x16_bf16 v[80:95], v[8:11], v[200:203], v[80:95]
v_cvt_pk_bf16_f32 v216, v216, v217
v_cvt_pk_bf16_f32 v217, v218, v219
v_cvt_pk_bf16_f32 v218, v220, v221
v_cvt_pk_bf16_f32 v219, v222, v223
ds_read_b64_tr_b16 v[112:113], v12 offset:20480
ds_read_b64_tr_b16 v[114:115], v12 offset:22528
ds_read_b64_tr_b16 v[116:117], v13 offset:20480
ds_read_b64_tr_b16 v[118:119], v13 offset:22528
s_waitcnt lgkmcnt(4)
v_mfma_f32_32x32x16_bf16 v[16:31], v[96:99], v[208:211], v[16:31]
ds_read_b64_tr_b16 v[120:121], v14 offset:20480
ds_read_b64_tr_b16 v[122:123], v14 offset:22528
ds_read_b64_tr_b16 v[124:125], v15 offset:20480
ds_read_b64_tr_b16 v[126:127], v15 offset:22528
v_fma_f32 v224, v224, s40, v7
v_mfma_f32_32x32x16_bf16 v[32:47], v[100:103], v[208:211], v[32:47]
v_fma_f32 v225, v225, s40, v7
v_fma_f32 v226, v226, s40, v7
v_fma_f32 v227, v227, s40, v7
v_fma_f32 v228, v228, s40, v7
v_fma_f32 v229, v229, s40, v7
v_mfma_f32_32x32x16_bf16 v[48:63], v[104:107], v[208:211], v[48:63]
v_fma_f32 v230, v230, s40, v7
v_fma_f32 v231, v231, s40, v7
v_exp_f32 v224, v224
v_exp_f32 v225, v225
v_exp_f32 v226, v226
v_mfma_f32_32x32x16_bf16 v[64:79], v[108:111], v[208:211], v[64:79]
v_exp_f32 v227, v227
v_exp_f32 v228, v228
v_exp_f32 v229, v229
v_exp_f32 v230, v230
v_exp_f32 v231, v231
v_mfma_f32_32x32x16_bf16 v[80:95], v[8:11], v[208:211], v[80:95]
v_cvt_pk_bf16_f32 v224, v224, v225
v_cvt_pk_bf16_f32 v225, v226, v227
v_cvt_pk_bf16_f32 v226, v228, v229
v_cvt_pk_bf16_f32 v227, v230, v231
s_waitcnt lgkmcnt(0)
s_barrier
ds_read_b64_tr_b16 v[96:97], v12 offset:32768
ds_read_b64_tr_b16 v[98:99], v12 offset:34816
ds_read_b64_tr_b16 v[100:101], v13 offset:32768
ds_read_b64_tr_b16 v[102:103], v13 offset:34816
v_mfma_f32_32x32x16_bf16 v[16:31], v[112:115], v[216:219], v[16:31]
ds_read_b64_tr_b16 v[104:105], v14 offset:32768
ds_read_b64_tr_b16 v[106:107], v14 offset:34816
ds_read_b64_tr_b16 v[108:109], v15 offset:32768
ds_read_b64_tr_b16 v[110:111], v15 offset:34816
v_fma_f32 v232, v232, s40, v7
v_mfma_f32_32x32x16_bf16 v[32:47], v[116:119], v[216:219], v[32:47]
v_fma_f32 v233, v233, s40, v7
v_fma_f32 v234, v234, s40, v7
v_fma_f32 v235, v235, s40, v7
v_fma_f32 v236, v236, s40, v7
v_fma_f32 v237, v237, s40, v7
v_mfma_f32_32x32x16_bf16 v[48:63], v[120:123], v[216:219], v[48:63]
v_fma_f32 v238, v238, s40, v7
v_fma_f32 v239, v239, s40, v7
v_exp_f32 v232, v232
v_exp_f32 v233, v233
v_exp_f32 v234, v234
v_mfma_f32_32x32x16_bf16 v[64:79], v[124:127], v[216:219], v[64:79]
v_exp_f32 v235, v235
v_exp_f32 v236, v236
v_exp_f32 v237, v237
v_exp_f32 v238, v238
v_exp_f32 v239, v239
v_mfma_f32_32x32x16_bf16 v[80:95], v[8:11], v[216:219], v[80:95]
v_cvt_pk_bf16_f32 v232, v232, v233
v_cvt_pk_bf16_f32 v233, v234, v235
v_cvt_pk_bf16_f32 v234, v236, v237
v_cvt_pk_bf16_f32 v235, v238, v239
ds_read_b64_tr_b16 v[112:113], v12 offset:36864
ds_read_b64_tr_b16 v[114:115], v12 offset:38912
ds_read_b64_tr_b16 v[116:117], v13 offset:36864
ds_read_b64_tr_b16 v[118:119], v13 offset:38912
s_waitcnt lgkmcnt(4)
v_mfma_f32_32x32x16_bf16 v[16:31], v[96:99], v[224:227], v[16:31]
ds_read_b64_tr_b16 v[120:121], v14 offset:36864
ds_read_b64_tr_b16 v[122:123], v14 offset:38912
ds_read_b64_tr_b16 v[124:125], v15 offset:36864
ds_read_b64_tr_b16 v[126:127], v15 offset:38912
v_fma_f32 v240, v240, s40, v7
v_mfma_f32_32x32x16_bf16 v[32:47], v[100:103], v[224:227], v[32:47]
v_fma_f32 v241, v241, s40, v7
v_fma_f32 v242, v242, s40, v7
v_fma_f32 v243, v243, s40, v7
v_fma_f32 v244, v244, s40, v7
v_fma_f32 v245, v245, s40, v7
v_mfma_f32_32x32x16_bf16 v[48:63], v[104:107], v[224:227], v[48:63]
v_fma_f32 v246, v246, s40, v7
v_fma_f32 v247, v247, s40, v7
v_exp_f32 v240, v240
v_exp_f32 v241, v241
v_exp_f32 v242, v242
v_mfma_f32_32x32x16_bf16 v[64:79], v[108:111], v[224:227], v[64:79]
v_exp_f32 v243, v243
v_exp_f32 v244, v244
v_exp_f32 v245, v245
v_exp_f32 v246, v246
v_exp_f32 v247, v247
v_mfma_f32_32x32x16_bf16 v[80:95], v[8:11], v[224:227], v[80:95]
v_cvt_pk_bf16_f32 v240, v240, v241
v_cvt_pk_bf16_f32 v241, v242, v243
v_cvt_pk_bf16_f32 v242, v244, v245
v_cvt_pk_bf16_f32 v243, v246, v247
s_waitcnt lgkmcnt(0)
s_barrier
ds_read_b64_tr_b16 v[96:97], v12 offset:49152
ds_read_b64_tr_b16 v[98:99], v12 offset:51200
ds_read_b64_tr_b16 v[100:101], v13 offset:49152
ds_read_b64_tr_b16 v[102:103], v13 offset:51200
v_mfma_f32_32x32x16_bf16 v[16:31], v[112:115], v[232:235], v[16:31]
ds_read_b64_tr_b16 v[104:105], v14 offset:49152
ds_read_b64_tr_b16 v[106:107], v14 offset:51200
ds_read_b64_tr_b16 v[108:109], v15 offset:49152
ds_read_b64_tr_b16 v[110:111], v15 offset:51200
v_fma_f32 v248, v248, s40, v7
v_mfma_f32_32x32x16_bf16 v[32:47], v[116:119], v[232:235], v[32:47]
v_fma_f32 v249, v249, s40, v7
v_fma_f32 v250, v250, s40, v7
v_fma_f32 v251, v251, s40, v7
v_fma_f32 v252, v252, s40, v7
v_fma_f32 v253, v253, s40, v7
v_mfma_f32_32x32x16_bf16 v[48:63], v[120:123], v[232:235], v[48:63]
v_fma_f32 v254, v254, s40, v7
v_fma_f32 v255, v255, s40, v7
v_exp_f32 v248, v248
v_exp_f32 v249, v249
v_exp_f32 v250, v250
v_mfma_f32_32x32x16_bf16 v[64:79], v[124:127], v[232:235], v[64:79]
v_exp_f32 v251, v251
v_exp_f32 v252, v252
v_exp_f32 v253, v253
v_exp_f32 v254, v254
v_exp_f32 v255, v255
v_mfma_f32_32x32x16_bf16 v[80:95], v[8:11], v[232:235], v[80:95]
v_cvt_pk_bf16_f32 v248, v248, v249
v_cvt_pk_bf16_f32 v249, v250, v251
v_cvt_pk_bf16_f32 v250, v252, v253
v_cvt_pk_bf16_f32 v251, v254, v255
ds_read_b64_tr_b16 v[112:113], v12 offset:53248
ds_read_b64_tr_b16 v[114:115], v12 offset:55296
ds_read_b64_tr_b16 v[116:117], v13 offset:53248
ds_read_b64_tr_b16 v[118:119], v13 offset:55296
s_waitcnt lgkmcnt(4)
v_mfma_f32_32x32x16_bf16 v[16:31], v[96:99], v[240:243], v[16:31]
ds_read_b64_tr_b16 v[120:121], v14 offset:53248
v_mfma_f32_32x32x16_bf16 v[32:47], v[100:103], v[240:243], v[32:47]
ds_read_b64_tr_b16 v[122:123], v14 offset:55296
v_mfma_f32_32x32x16_bf16 v[48:63], v[104:107], v[240:243], v[48:63]
ds_read_b64_tr_b16 v[124:125], v15 offset:53248
v_mfma_f32_32x32x16_bf16 v[64:79], v[108:111], v[240:243], v[64:79]
ds_read_b64_tr_b16 v[126:127], v15 offset:55296
v_mfma_f32_32x32x16_bf16 v[80:95], v[8:11], v[240:243], v[80:95]
s_waitcnt lgkmcnt(0)
v_mfma_f32_32x32x16_bf16 v[16:31], v[112:115], v[248:251], v[16:31]
v_mfma_f32_32x32x16_bf16 v[32:47], v[116:119], v[248:251], v[32:47]
v_mfma_f32_32x32x16_bf16 v[48:63], v[120:123], v[248:251], v[48:63]
v_mfma_f32_32x32x16_bf16 v[64:79], v[124:127], v[248:251], v[64:79]
v_mfma_f32_32x32x16_bf16 v[80:95], v[8:11], v[248:251], v[80:95]
v_lshlrev_b32 v7, 4, v2
s_lshl_b32 s28, s16, 13
v_add_u32 v4, s28, v7
v_add_u32 v4, 81920, v4
s_xor_b32 s29, s16, 2
s_lshl_b32 s28, s29, 13
v_add_u32 v5, s28, v7
v_add_u32 v5, 81920, v5
v_lshlrev_b32 v12, 2, v2
s_lshl_b32 s28, s16, 8
v_add_u32 v3, s28, v12
v_add_u32 v3, 147456, v3
s_lshl_b32 s28, s29, 8
v_add_u32 v6, s28, v12
v_add_u32 v6, 147456, v6
v_bfe_u32 v9, v2, 4, 1
v_lshlrev_b32 v9, 10, v9
v_lshrrev_b32 v10, 5, v2
v_lshl_add_u32 v9, v10, 8, v9
v_and_b32 v10, 15, v2
v_lshl_add_u32 v9, v10, 4, v9

ds_write_b128 v4, v[48:51] offset:0
ds_write_b128 v4, v[52:55] offset:1024
ds_write_b128 v4, v[56:59] offset:2048
ds_write_b128 v4, v[60:63] offset:3072
v_add_u32 v13, s98, v9
v_add_u32 v13, 147456, v13
v_lshrrev_b32 v14, 5, v2
v_lshlrev_b32 v14, 4, v14

ds_write_b128 v4, v[64:67] offset:4096
ds_write_b128 v4, v[68:71] offset:5120
ds_write_b128 v4, v[72:75] offset:6144
ds_write_b128 v4, v[76:79] offset:7168
ds_write_b32 v3, v80
v_bfe_u32 v15, v2, 4, 1
v_lshlrev_b32 v15, 2, v15
v_bfe_u32 v113, v2, 2, 2
v_add_u32 v15, v15, v113
v_add_u32 v14, v14, v15
v_and_b32 v113, 3, v2
v_lshlrev_b32 v113, 3, v113
v_lshl_add_u32 v120, v14, 7, v113
v_lshrrev_b32 v121, 1, v15
s_lshl_b32 s28, s47, 1
v_xor_b32 v121, s28, v121
v_lshl_add_u32 v122, v121, 5, v120
v_add_u32 v122, 131072, v122
v_xor_b32 v121, 1, v121
v_lshl_add_u32 v123, v121, 5, v120
v_add_u32 v123, 131072, v123
v_lshl_add_u32 v14, v14, 8, v113
s_lshl_b32 s28, s47, 2
v_xor_b32 v15, s28, v15
v_lshl_add_u32 v112, v15, 5, v14
v_xor_b32 v113, 1, v15
v_lshl_add_u32 v113, v113, 5, v14
v_xor_b32 v114, 2, v15
v_lshl_add_u32 v114, v114, 5, v14
v_xor_b32 v115, 3, v15
v_lshl_add_u32 v115, v115, 5, v14
v_add_u32 v116, 65536, v112
v_add_u32 v117, 65536, v113
v_add_u32 v118, 65536, v114
v_add_u32 v119, 65536, v115
s_mov_b32 s45, 0

K_xcc_chk:
s_waitcnt vmcnt(0)
v_and_b32 v10, 0xfffffff8, v1
v_cmp_ne_u32 vcc, s50, v10
s_cmp_eq_u64 vcc, 0
s_cbranch_scc1 K_xcc_ok
s_add_u32 s45, s45, 1
s_cmp_gt_u32 s45, 0x40000
s_cbranch_scc1 K_xcc_ok
s_sleep 1
v_lshlrev_b32 v1, 2, v2
v_and_b32 v1, 12, v1
buffer_load_dword v1, v1, s[20:23], s51 offen sc1
s_branch K_xcc_chk

K_xcc_ok:
v_readfirstlane_b32 s28, v1
s_lshl_b32 s29, s31, 2
s_add_u32 s29, s29, s16
v_cmp_ne_u32 vcc, s28, v1
s_lshl_b32 s29, s29, 2
s_cmp_eq_u64 vcc, 0
s_cselect_b32 s53, 1, 0
v_mov_b32 v10, s29
v_mov_b32 v11, s50
s_waitcnt lgkmcnt(0)

s_barrier
ds_read_b128 v[128:131], v5 offset:0
ds_read_b128 v[132:135], v5 offset:1024
ds_read_b128 v[136:139], v5 offset:2048
ds_read_b128 v[140:143], v5 offset:3072
ds_read_b128 v[144:147], v5 offset:4096
ds_read_b128 v[148:151], v5 offset:5120
ds_read_b128 v[152:155], v5 offset:6144
ds_read_b128 v[156:159], v5 offset:7168
ds_read_b32 v8, v6
s_lshl_b32 s28, s47, 10
v_add_u32 v4, 1024, v7
v_subrev_u32 v4, s28, v4
v_add_u32 v3, s28, v7
s_lshl_b32 s28, s30, 11
s_add_u32 s28, s28, 147456
s_waitcnt lgkmcnt(0)
v_add_u32 v5, s28, v3
v_add_u32 v6, s28, v4

s_barrier
v_add_f32 v8, v8, v80
v_rcp_f32 v8, v8
v_pk_add_f32 v[16:17], v[16:17], v[128:129]
v_pk_add_f32 v[18:19], v[18:19], v[130:131]
v_pk_add_f32 v[20:21], v[20:21], v[132:133]
v_pk_add_f32 v[22:23], v[22:23], v[134:135]
v_pk_mul_f32 v[16:17], v[16:17], v[8:9] op_sel_hi:[1,0]
v_pk_mul_f32 v[18:19], v[18:19], v[8:9] op_sel_hi:[1,0]
v_pk_mul_f32 v[20:21], v[20:21], v[8:9] op_sel_hi:[1,0]
v_pk_mul_f32 v[22:23], v[22:23], v[8:9] op_sel_hi:[1,0]
v_cvt_pk_bf16_f32 v48, v16, v17
v_cvt_pk_bf16_f32 v49, v18, v19
v_cvt_pk_bf16_f32 v50, v20, v21
v_cvt_pk_bf16_f32 v51, v22, v23
v_pk_add_f32 v[24:25], v[24:25], v[136:137]
v_pk_add_f32 v[26:27], v[26:27], v[138:139]
v_pk_add_f32 v[28:29], v[28:29], v[140:141]
v_pk_add_f32 v[30:31], v[30:31], v[142:143]
v_pk_mul_f32 v[24:25], v[24:25], v[8:9] op_sel_hi:[1,0]
v_pk_mul_f32 v[26:27], v[26:27], v[8:9] op_sel_hi:[1,0]
v_pk_mul_f32 v[28:29], v[28:29], v[8:9] op_sel_hi:[1,0]
v_pk_mul_f32 v[30:31], v[30:31], v[8:9] op_sel_hi:[1,0]
v_cvt_pk_bf16_f32 v52, v24, v25
v_cvt_pk_bf16_f32 v53, v26, v27
v_cvt_pk_bf16_f32 v54, v28, v29
v_cvt_pk_bf16_f32 v55, v30, v31
v_pk_add_f32 v[32:33], v[32:33], v[144:145]
v_pk_add_f32 v[34:35], v[34:35], v[146:147]
v_pk_add_f32 v[36:37], v[36:37], v[148:149]
v_pk_add_f32 v[38:39], v[38:39], v[150:151]
v_pk_mul_f32 v[32:33], v[32:33], v[8:9] op_sel_hi:[1,0]
v_pk_mul_f32 v[34:35], v[34:35], v[8:9] op_sel_hi:[1,0]
v_pk_mul_f32 v[36:37], v[36:37], v[8:9] op_sel_hi:[1,0]
v_pk_mul_f32 v[38:39], v[38:39], v[8:9] op_sel_hi:[1,0]
v_cvt_pk_bf16_f32 v56, v32, v33
v_cvt_pk_bf16_f32 v57, v34, v35
v_cvt_pk_bf16_f32 v58, v36, v37
v_cvt_pk_bf16_f32 v59, v38, v39
v_pk_add_f32 v[40:41], v[40:41], v[152:153]
v_pk_add_f32 v[42:43], v[42:43], v[154:155]
v_pk_add_f32 v[44:45], v[44:45], v[156:157]
v_pk_add_f32 v[46:47], v[46:47], v[158:159]
v_pk_mul_f32 v[40:41], v[40:41], v[8:9] op_sel_hi:[1,0]
v_pk_mul_f32 v[42:43], v[42:43], v[8:9] op_sel_hi:[1,0]
v_pk_mul_f32 v[44:45], v[44:45], v[8:9] op_sel_hi:[1,0]
v_pk_mul_f32 v[46:47], v[46:47], v[8:9] op_sel_hi:[1,0]
v_cvt_pk_bf16_f32 v60, v40, v41
v_cvt_pk_bf16_f32 v61, v42, v43
v_cvt_pk_bf16_f32 v62, v44, v45
v_cvt_pk_bf16_f32 v63, v46, v47
s_cmp_eq_u32 s53, 1
s_cbranch_scc1 K_ost_fast
buffer_store_dwordx4 v[48:51], v9, s[20:23], s96 offen offset:0 sc1
buffer_store_dwordx4 v[52:55], v9, s[20:23], s96 offen offset:512 sc1
buffer_store_dwordx4 v[56:59], v9, s[20:23], s97 offen offset:0 sc1
buffer_store_dwordx4 v[60:63], v9, s[20:23], s97 offen offset:512 sc1
s_branch K_ost_done
K_ost_fast:
buffer_store_dwordx4 v[48:51], v9, s[20:23], s96 offen offset:0
buffer_store_dwordx4 v[52:55], v9, s[20:23], s96 offen offset:512
buffer_store_dwordx4 v[56:59], v9, s[20:23], s97 offen offset:0
buffer_store_dwordx4 v[60:63], v9, s[20:23], s97 offen offset:512
K_ost_done:
ds_write_b128 v13, v[48:51] offset:0
ds_write_b128 v13, v[52:55] offset:512
ds_write_b128 v13, v[56:59] offset:4096
ds_write_b128 v13, v[60:63] offset:4608
s_waitcnt lgkmcnt(0)
s_barrier
ds_read_b128 v[128:131], v5 offset:0
ds_read_b128 v[132:135], v6 offset:0
ds_read_b128 v[136:139], v5 offset:4096
ds_read_b128 v[140:143], v6 offset:4096
ds_read_b128 v[144:147], v5 offset:8192
ds_read_b128 v[148:151], v6 offset:8192
ds_read_b128 v[152:155], v5 offset:12288
ds_read_b128 v[156:159], v6 offset:12288
ds_read_b64_tr_b16 v[16:17], v122 offset:0
ds_read_b64_tr_b16 v[18:19], v122 offset:1024
ds_read_b64_tr_b16 v[20:21], v123 offset:0
ds_read_b64_tr_b16 v[22:23], v123 offset:1024
ds_read_b64_tr_b16 v[24:25], v122 offset:4096
ds_read_b64_tr_b16 v[26:27], v122 offset:5120
ds_read_b64_tr_b16 v[28:29], v123 offset:4096
s_waitcnt lgkmcnt(7)
ds_read_b64_tr_b16 v[30:31], v123 offset:5120
ds_read_b64_tr_b16 v[32:33], v122 offset:8192
ds_read_b64_tr_b16 v[34:35], v122 offset:9216
ds_read_b64_tr_b16 v[36:37], v123 offset:8192
ds_read_b64_tr_b16 v[38:39], v123 offset:9216
ds_read_b64_tr_b16 v[40:41], v122 offset:12288
ds_read_b64_tr_b16 v[42:43], v122 offset:13312
ds_read_b64_tr_b16 v[44:45], v123 offset:12288
s_waitcnt lgkmcnt(11)
ds_read_b64_tr_b16 v[46:47], v123 offset:13312
s_waitcnt vmcnt(0)
v_cmp_eq_u32 vcc, 0, v2
s_and_saveexec_b64 s[38:39], vcc
s_cmp_eq_u32 s53, 1
s_cbranch_scc1 K_fl_fast
buffer_store_dword v11, v10, s[20:23], s52 offen sc1
s_branch K_fl_done
K_fl_fast:
buffer_store_dword v11, v10, s[20:23], s52 offen
K_fl_done:
s_mov_b64 exec, s[38:39]
s_waitcnt lgkmcnt(12)
v_mfma_f32_16x16x32_bf16 v[96:99], v[16:19], v[128:131], 0
v_mfma_f32_16x16x32_bf16 v[100:103], v[16:19], v[132:135], 0
v_mfma_f32_16x16x32_bf16 v[104:107], v[20:23], v[128:131], 0
v_mfma_f32_16x16x32_bf16 v[108:111], v[20:23], v[132:135], 0
s_waitcnt lgkmcnt(8)
v_mfma_f32_16x16x32_bf16 v[96:99], v[24:27], v[136:139], v[96:99]
v_mfma_f32_16x16x32_bf16 v[100:103], v[24:27], v[140:143], v[100:103]
v_mfma_f32_16x16x32_bf16 v[104:107], v[28:31], v[136:139], v[104:107]
v_mfma_f32_16x16x32_bf16 v[108:111], v[28:31], v[140:143], v[108:111]
s_waitcnt lgkmcnt(4)
v_mfma_f32_16x16x32_bf16 v[96:99], v[32:35], v[144:147], v[96:99]
v_mfma_f32_16x16x32_bf16 v[100:103], v[32:35], v[148:151], v[100:103]
v_mfma_f32_16x16x32_bf16 v[104:107], v[36:39], v[144:147], v[104:107]
v_mfma_f32_16x16x32_bf16 v[108:111], v[36:39], v[148:151], v[108:111]
s_waitcnt lgkmcnt(0)
v_mfma_f32_16x16x32_bf16 v[96:99], v[40:43], v[152:155], v[96:99]
v_mfma_f32_16x16x32_bf16 v[100:103], v[40:43], v[156:159], v[100:103]
v_mfma_f32_16x16x32_bf16 v[104:107], v[44:47], v[152:155], v[104:107]
v_mfma_f32_16x16x32_bf16 v[108:111], v[44:47], v[156:159], v[108:111]
ds_read_b64_tr_b16 v[16:17], v112 offset:0
ds_read_b64_tr_b16 v[18:19], v112 offset:2048
ds_read_b64_tr_b16 v[20:21], v113 offset:0
ds_read_b64_tr_b16 v[22:23], v113 offset:2048
ds_read_b64_tr_b16 v[24:25], v114 offset:0
ds_read_b64_tr_b16 v[26:27], v114 offset:2048
ds_read_b64_tr_b16 v[28:29], v115 offset:0
ds_read_b64_tr_b16 v[30:31], v115 offset:2048
ds_read_b64_tr_b16 v[32:33], v112 offset:8192
ds_read_b64_tr_b16 v[34:35], v112 offset:10240
ds_read_b64_tr_b16 v[36:37], v113 offset:8192
ds_read_b64_tr_b16 v[38:39], v113 offset:10240
ds_read_b64_tr_b16 v[40:41], v114 offset:8192
ds_read_b64_tr_b16 v[42:43], v114 offset:10240
ds_read_b64_tr_b16 v[44:45], v115 offset:8192
s_waitcnt lgkmcnt(7)
ds_read_b64_tr_b16 v[46:47], v115 offset:10240
s_waitcnt lgkmcnt(8)
v_mfma_f32_16x16x32_bf16 v[64:67], v[16:19], v[128:131], 0
ds_read_b64_tr_b16 v[48:49], v112 offset:16384
v_mfma_f32_16x16x32_bf16 v[68:71], v[16:19], v[132:135], 0
ds_read_b64_tr_b16 v[50:51], v112 offset:18432
v_mfma_f32_16x16x32_bf16 v[72:75], v[20:23], v[128:131], 0
ds_read_b64_tr_b16 v[52:53], v113 offset:16384
v_mfma_f32_16x16x32_bf16 v[76:79], v[20:23], v[132:135], 0
ds_read_b64_tr_b16 v[54:55], v113 offset:18432
v_mfma_f32_16x16x32_bf16 v[80:83], v[24:27], v[128:131], 0
ds_read_b64_tr_b16 v[56:57], v114 offset:16384
v_mfma_f32_16x16x32_bf16 v[84:87], v[24:27], v[132:135], 0
ds_read_b64_tr_b16 v[58:59], v114 offset:18432
v_mfma_f32_16x16x32_bf16 v[88:91], v[28:31], v[128:131], 0
ds_read_b64_tr_b16 v[60:61], v115 offset:16384
v_mfma_f32_16x16x32_bf16 v[92:95], v[28:31], v[132:135], 0
s_waitcnt lgkmcnt(14)
ds_read_b64_tr_b16 v[62:63], v115 offset:18432
s_waitcnt lgkmcnt(8)
v_mfma_f32_16x16x32_bf16 v[64:67], v[32:35], v[136:139], v[64:67]
ds_read_b64_tr_b16 v[16:17], v112 offset:24576
v_mfma_f32_16x16x32_bf16 v[68:71], v[32:35], v[140:143], v[68:71]
ds_read_b64_tr_b16 v[18:19], v112 offset:26624
v_mfma_f32_16x16x32_bf16 v[72:75], v[36:39], v[136:139], v[72:75]
ds_read_b64_tr_b16 v[20:21], v113 offset:24576
v_mfma_f32_16x16x32_bf16 v[76:79], v[36:39], v[140:143], v[76:79]
ds_read_b64_tr_b16 v[22:23], v113 offset:26624
v_mfma_f32_16x16x32_bf16 v[80:83], v[40:43], v[136:139], v[80:83]
ds_read_b64_tr_b16 v[24:25], v114 offset:24576
v_mfma_f32_16x16x32_bf16 v[84:87], v[40:43], v[140:143], v[84:87]
ds_read_b64_tr_b16 v[26:27], v114 offset:26624
v_mfma_f32_16x16x32_bf16 v[88:91], v[44:47], v[136:139], v[88:91]
ds_read_b64_tr_b16 v[28:29], v115 offset:24576
v_mfma_f32_16x16x32_bf16 v[92:95], v[44:47], v[140:143], v[92:95]
s_waitcnt lgkmcnt(14)
ds_read_b64_tr_b16 v[30:31], v115 offset:26624
v_cmp_gt_u32 vcc, 16, v2
s_and_b64 s[38:39], vcc, exec
s_mov_b64 exec, s[38:39]
buffer_load_dword v10, v12, s[20:23], s52 offen sc1
s_mov_b64 exec, -1
s_waitcnt lgkmcnt(8)
v_mfma_f32_16x16x32_bf16 v[64:67], v[48:51], v[144:147], v[64:67]
ds_read_b64_tr_b16 v[32:33], v112 offset:32768
v_mfma_f32_16x16x32_bf16 v[68:71], v[48:51], v[148:151], v[68:71]
ds_read_b64_tr_b16 v[34:35], v112 offset:34816
v_mfma_f32_16x16x32_bf16 v[72:75], v[52:55], v[144:147], v[72:75]
ds_read_b64_tr_b16 v[36:37], v113 offset:32768
v_mfma_f32_16x16x32_bf16 v[76:79], v[52:55], v[148:151], v[76:79]
ds_read_b64_tr_b16 v[38:39], v113 offset:34816
v_mfma_f32_16x16x32_bf16 v[80:83], v[56:59], v[144:147], v[80:83]
ds_read_b64_tr_b16 v[40:41], v114 offset:32768
v_mfma_f32_16x16x32_bf16 v[84:87], v[56:59], v[148:151], v[84:87]
ds_read_b64_tr_b16 v[42:43], v114 offset:34816
v_mfma_f32_16x16x32_bf16 v[88:91], v[60:63], v[144:147], v[88:91]
ds_read_b64_tr_b16 v[44:45], v115 offset:32768
v_mfma_f32_16x16x32_bf16 v[92:95], v[60:63], v[148:151], v[92:95]
s_waitcnt lgkmcnt(14)
ds_read_b64_tr_b16 v[46:47], v115 offset:34816
s_waitcnt lgkmcnt(8)
v_mfma_f32_16x16x32_bf16 v[64:67], v[16:19], v[152:155], v[64:67]
ds_read_b64_tr_b16 v[48:49], v112 offset:40960
v_mfma_f32_16x16x32_bf16 v[68:71], v[16:19], v[156:159], v[68:71]
ds_read_b64_tr_b16 v[50:51], v112 offset:43008
v_mfma_f32_16x16x32_bf16 v[72:75], v[20:23], v[152:155], v[72:75]
ds_read_b64_tr_b16 v[52:53], v113 offset:40960
v_mfma_f32_16x16x32_bf16 v[76:79], v[20:23], v[156:159], v[76:79]
ds_read_b64_tr_b16 v[54:55], v113 offset:43008
v_mfma_f32_16x16x32_bf16 v[80:83], v[24:27], v[152:155], v[80:83]
ds_read_b64_tr_b16 v[56:57], v114 offset:40960
v_mfma_f32_16x16x32_bf16 v[84:87], v[24:27], v[156:159], v[84:87]
ds_read_b64_tr_b16 v[58:59], v114 offset:43008
v_mfma_f32_16x16x32_bf16 v[88:91], v[28:31], v[152:155], v[88:91]
ds_read_b64_tr_b16 v[60:61], v115 offset:40960
v_mfma_f32_16x16x32_bf16 v[92:95], v[28:31], v[156:159], v[92:95]
s_waitcnt lgkmcnt(14)
ds_read_b64_tr_b16 v[62:63], v115 offset:43008
s_mov_b64 exec, s[38:39]
s_waitcnt vmcnt(0)
v_cmp_ne_u32 vcc, s50, v10
s_mov_b64 exec, -1
s_cmp_eq_u64 vcc, 0
s_cbranch_scc1 K_polldone1
s_mov_b32 s45, 0
v_cmp_gt_u32 vcc, 16, v2
s_and_b64 s[38:39], vcc, exec

K_poll1:
s_mov_b64 exec, s[38:39]
buffer_load_dword v10, v12, s[20:23], s52 offen sc1
s_waitcnt vmcnt(0)
v_cmp_ne_u32 vcc, s50, v10
s_mov_b64 exec, -1
s_cmp_eq_u64 vcc, 0
s_cbranch_scc1 K_polldone1
s_add_u32 s45, s45, 1
s_cmp_gt_u32 s45, 0x40000
s_cbranch_scc1 K_polldone1
s_sleep 1
s_branch K_poll1

K_polldone1:
s_add_u32 s28, s31, 1
s_and_b32 s28, s28, 3
s_lshl_b32 s28, s28, 14
s_add_u32 s40, s28, s99
s_add_u32 s28, s31, 2
s_and_b32 s28, s28, 3
s_lshl_b32 s28, s28, 14
s_add_u32 s41, s28, s99
s_add_u32 s28, s31, 3
s_and_b32 s28, s28, 3
s_lshl_b32 s28, s28, 14
s_add_u32 s42, s28, s99
s_add_u32 s28, s40, 0
buffer_load_dwordx4 v[160:163], v3, s[20:23], s28 offen sc1
buffer_load_dwordx4 v[164:167], v4, s[20:23], s28 offen sc1
s_add_u32 s28, s40, 4096
buffer_load_dwordx4 v[168:171], v3, s[20:23], s28 offen sc1
buffer_load_dwordx4 v[172:175], v4, s[20:23], s28 offen sc1
s_add_u32 s28, s40, 8192
buffer_load_dwordx4 v[176:179], v3, s[20:23], s28 offen sc1
buffer_load_dwordx4 v[180:183], v4, s[20:23], s28 offen sc1
s_add_u32 s28, s40, 12288
buffer_load_dwordx4 v[184:187], v3, s[20:23], s28 offen sc1
buffer_load_dwordx4 v[188:191], v4, s[20:23], s28 offen sc1
v_cvt_pk_bf16_f32 v124, v96, v97
v_cvt_pk_bf16_f32 v125, v98, v99
v_cvt_pk_bf16_f32 v126, v100, v101
v_cvt_pk_bf16_f32 v127, v102, v103
buffer_store_dwordx4 v[124:127], v7, s[20:23], s101 offen offset:0 sc1
v_cvt_pk_bf16_f32 v96, v104, v105
v_cvt_pk_bf16_f32 v97, v106, v107
v_cvt_pk_bf16_f32 v98, v108, v109
v_cvt_pk_bf16_f32 v99, v110, v111
buffer_store_dwordx4 v[96:99], v7, s[20:23], s101 offen offset:1024 sc1
s_waitcnt vmcnt(8) lgkmcnt(8)
v_mfma_f32_16x16x32_bf16 v[64:67], v[32:35], v[160:163], v[64:67]
s_add_u32 s28, s41, 0
buffer_load_dwordx4 v[192:195], v3, s[20:23], s28 offen sc1
buffer_load_dwordx4 v[196:199], v4, s[20:23], s28 offen sc1
ds_read_b64_tr_b16 v[16:17], v112 offset:49152
v_mfma_f32_16x16x32_bf16 v[68:71], v[32:35], v[164:167], v[68:71]
ds_read_b64_tr_b16 v[18:19], v112 offset:51200
v_mfma_f32_16x16x32_bf16 v[72:75], v[36:39], v[160:163], v[72:75]
ds_read_b64_tr_b16 v[20:21], v113 offset:49152
v_mfma_f32_16x16x32_bf16 v[76:79], v[36:39], v[164:167], v[76:79]
ds_read_b64_tr_b16 v[22:23], v113 offset:51200
v_mfma_f32_16x16x32_bf16 v[80:83], v[40:43], v[160:163], v[80:83]
ds_read_b64_tr_b16 v[24:25], v114 offset:49152
v_mfma_f32_16x16x32_bf16 v[84:87], v[40:43], v[164:167], v[84:87]
ds_read_b64_tr_b16 v[26:27], v114 offset:51200
v_mfma_f32_16x16x32_bf16 v[88:91], v[44:47], v[160:163], v[88:91]
ds_read_b64_tr_b16 v[28:29], v115 offset:49152
v_mfma_f32_16x16x32_bf16 v[92:95], v[44:47], v[164:167], v[92:95]
s_waitcnt lgkmcnt(14)
ds_read_b64_tr_b16 v[30:31], v115 offset:51200
s_waitcnt vmcnt(8) lgkmcnt(8)
v_mfma_f32_16x16x32_bf16 v[64:67], v[48:51], v[168:171], v[64:67]
s_add_u32 s28, s41, 4096
buffer_load_dwordx4 v[200:203], v3, s[20:23], s28 offen sc1
buffer_load_dwordx4 v[204:207], v4, s[20:23], s28 offen sc1
ds_read_b64_tr_b16 v[32:33], v112 offset:57344
v_mfma_f32_16x16x32_bf16 v[68:71], v[48:51], v[172:175], v[68:71]
ds_read_b64_tr_b16 v[34:35], v112 offset:59392
v_mfma_f32_16x16x32_bf16 v[72:75], v[52:55], v[168:171], v[72:75]
ds_read_b64_tr_b16 v[36:37], v113 offset:57344
v_mfma_f32_16x16x32_bf16 v[76:79], v[52:55], v[172:175], v[76:79]
ds_read_b64_tr_b16 v[38:39], v113 offset:59392
v_mfma_f32_16x16x32_bf16 v[80:83], v[56:59], v[168:171], v[80:83]
ds_read_b64_tr_b16 v[40:41], v114 offset:57344
v_mfma_f32_16x16x32_bf16 v[84:87], v[56:59], v[172:175], v[84:87]
ds_read_b64_tr_b16 v[42:43], v114 offset:59392
v_mfma_f32_16x16x32_bf16 v[88:91], v[60:63], v[168:171], v[88:91]
ds_read_b64_tr_b16 v[44:45], v115 offset:57344
v_mfma_f32_16x16x32_bf16 v[92:95], v[60:63], v[172:175], v[92:95]
s_waitcnt lgkmcnt(14)
ds_read_b64_tr_b16 v[46:47], v115 offset:59392
s_waitcnt vmcnt(8) lgkmcnt(8)
v_mfma_f32_16x16x32_bf16 v[64:67], v[16:19], v[176:179], v[64:67]
s_add_u32 s28, s41, 8192
buffer_load_dwordx4 v[208:211], v3, s[20:23], s28 offen sc1
buffer_load_dwordx4 v[212:215], v4, s[20:23], s28 offen sc1
ds_read_b64_tr_b16 v[48:49], v116 offset:0
v_mfma_f32_16x16x32_bf16 v[68:71], v[16:19], v[180:183], v[68:71]
ds_read_b64_tr_b16 v[50:51], v116 offset:2048
v_mfma_f32_16x16x32_bf16 v[72:75], v[20:23], v[176:179], v[72:75]
ds_read_b64_tr_b16 v[52:53], v117 offset:0
v_mfma_f32_16x16x32_bf16 v[76:79], v[20:23], v[180:183], v[76:79]
ds_read_b64_tr_b16 v[54:55], v117 offset:2048
v_mfma_f32_16x16x32_bf16 v[80:83], v[24:27], v[176:179], v[80:83]
ds_read_b64_tr_b16 v[56:57], v118 offset:0
v_mfma_f32_16x16x32_bf16 v[84:87], v[24:27], v[180:183], v[84:87]
ds_read_b64_tr_b16 v[58:59], v118 offset:2048
v_mfma_f32_16x16x32_bf16 v[88:91], v[28:31], v[176:179], v[88:91]
ds_read_b64_tr_b16 v[60:61], v119 offset:0
v_mfma_f32_16x16x32_bf16 v[92:95], v[28:31], v[180:183], v[92:95]
s_waitcnt lgkmcnt(14)
ds_read_b64_tr_b16 v[62:63], v119 offset:2048
s_waitcnt vmcnt(8) lgkmcnt(8)
v_mfma_f32_16x16x32_bf16 v[64:67], v[32:35], v[184:187], v[64:67]
s_add_u32 s28, s41, 12288
buffer_load_dwordx4 v[216:219], v3, s[20:23], s28 offen sc1
buffer_load_dwordx4 v[220:223], v4, s[20:23], s28 offen sc1
ds_read_b64_tr_b16 v[16:17], v116 offset:8192
v_mfma_f32_16x16x32_bf16 v[68:71], v[32:35], v[188:191], v[68:71]
ds_read_b64_tr_b16 v[18:19], v116 offset:10240
v_mfma_f32_16x16x32_bf16 v[72:75], v[36:39], v[184:187], v[72:75]
ds_read_b64_tr_b16 v[20:21], v117 offset:8192
v_mfma_f32_16x16x32_bf16 v[76:79], v[36:39], v[188:191], v[76:79]
ds_read_b64_tr_b16 v[22:23], v117 offset:10240
v_mfma_f32_16x16x32_bf16 v[80:83], v[40:43], v[184:187], v[80:83]
ds_read_b64_tr_b16 v[24:25], v118 offset:8192
v_mfma_f32_16x16x32_bf16 v[84:87], v[40:43], v[188:191], v[84:87]
ds_read_b64_tr_b16 v[26:27], v118 offset:10240
v_mfma_f32_16x16x32_bf16 v[88:91], v[44:47], v[184:187], v[88:91]
ds_read_b64_tr_b16 v[28:29], v119 offset:8192
v_mfma_f32_16x16x32_bf16 v[92:95], v[44:47], v[188:191], v[92:95]
s_waitcnt lgkmcnt(14)
ds_read_b64_tr_b16 v[30:31], v119 offset:10240
s_barrier
s_waitcnt vmcnt(6) lgkmcnt(8)
v_mfma_f32_16x16x32_bf16 v[64:67], v[48:51], v[192:195], v[64:67]
s_add_u32 s28, s42, 0
buffer_load_dwordx4 v[224:227], v3, s[20:23], s28 offen sc1
buffer_load_dwordx4 v[228:231], v4, s[20:23], s28 offen sc1
ds_read_b64_tr_b16 v[32:33], v116 offset:16384
v_mfma_f32_16x16x32_bf16 v[68:71], v[48:51], v[196:199], v[68:71]
ds_read_b64_tr_b16 v[34:35], v116 offset:18432
v_mfma_f32_16x16x32_bf16 v[72:75], v[52:55], v[192:195], v[72:75]
ds_read_b64_tr_b16 v[36:37], v117 offset:16384
v_mfma_f32_16x16x32_bf16 v[76:79], v[52:55], v[196:199], v[76:79]
ds_read_b64_tr_b16 v[38:39], v117 offset:18432
v_mfma_f32_16x16x32_bf16 v[80:83], v[56:59], v[192:195], v[80:83]
ds_read_b64_tr_b16 v[40:41], v118 offset:16384
v_mfma_f32_16x16x32_bf16 v[84:87], v[56:59], v[196:199], v[84:87]
ds_read_b64_tr_b16 v[42:43], v118 offset:18432
v_mfma_f32_16x16x32_bf16 v[88:91], v[60:63], v[192:195], v[88:91]
ds_read_b64_tr_b16 v[44:45], v119 offset:16384
v_mfma_f32_16x16x32_bf16 v[92:95], v[60:63], v[196:199], v[92:95]
s_waitcnt lgkmcnt(14)
ds_read_b64_tr_b16 v[46:47], v119 offset:18432
s_waitcnt vmcnt(6) lgkmcnt(8)
v_mfma_f32_16x16x32_bf16 v[64:67], v[16:19], v[200:203], v[64:67]
s_add_u32 s28, s42, 4096
buffer_load_dwordx4 v[232:235], v3, s[20:23], s28 offen sc1
buffer_load_dwordx4 v[236:239], v4, s[20:23], s28 offen sc1
ds_read_b64_tr_b16 v[48:49], v116 offset:24576
v_mfma_f32_16x16x32_bf16 v[68:71], v[16:19], v[204:207], v[68:71]
ds_read_b64_tr_b16 v[50:51], v116 offset:26624
v_mfma_f32_16x16x32_bf16 v[72:75], v[20:23], v[200:203], v[72:75]
ds_read_b64_tr_b16 v[52:53], v117 offset:24576
v_mfma_f32_16x16x32_bf16 v[76:79], v[20:23], v[204:207], v[76:79]
ds_read_b64_tr_b16 v[54:55], v117 offset:26624
v_mfma_f32_16x16x32_bf16 v[80:83], v[24:27], v[200:203], v[80:83]
ds_read_b64_tr_b16 v[56:57], v118 offset:24576
v_mfma_f32_16x16x32_bf16 v[84:87], v[24:27], v[204:207], v[84:87]
ds_read_b64_tr_b16 v[58:59], v118 offset:26624
v_mfma_f32_16x16x32_bf16 v[88:91], v[28:31], v[200:203], v[88:91]
ds_read_b64_tr_b16 v[60:61], v119 offset:24576
v_mfma_f32_16x16x32_bf16 v[92:95], v[28:31], v[204:207], v[92:95]
s_waitcnt lgkmcnt(14)
ds_read_b64_tr_b16 v[62:63], v119 offset:26624
s_waitcnt vmcnt(6) lgkmcnt(8)
v_mfma_f32_16x16x32_bf16 v[64:67], v[32:35], v[208:211], v[64:67]
s_add_u32 s28, s42, 8192
buffer_load_dwordx4 v[240:243], v3, s[20:23], s28 offen sc1
buffer_load_dwordx4 v[244:247], v4, s[20:23], s28 offen sc1
ds_read_b64_tr_b16 v[16:17], v116 offset:32768
v_mfma_f32_16x16x32_bf16 v[68:71], v[32:35], v[212:215], v[68:71]
ds_read_b64_tr_b16 v[18:19], v116 offset:34816
v_mfma_f32_16x16x32_bf16 v[72:75], v[36:39], v[208:211], v[72:75]
ds_read_b64_tr_b16 v[20:21], v117 offset:32768
v_mfma_f32_16x16x32_bf16 v[76:79], v[36:39], v[212:215], v[76:79]
ds_read_b64_tr_b16 v[22:23], v117 offset:34816
v_mfma_f32_16x16x32_bf16 v[80:83], v[40:43], v[208:211], v[80:83]
ds_read_b64_tr_b16 v[24:25], v118 offset:32768
v_mfma_f32_16x16x32_bf16 v[84:87], v[40:43], v[212:215], v[84:87]
ds_read_b64_tr_b16 v[26:27], v118 offset:34816
v_mfma_f32_16x16x32_bf16 v[88:91], v[44:47], v[208:211], v[88:91]
ds_read_b64_tr_b16 v[28:29], v119 offset:32768
v_mfma_f32_16x16x32_bf16 v[92:95], v[44:47], v[212:215], v[92:95]
s_waitcnt lgkmcnt(14)
ds_read_b64_tr_b16 v[30:31], v119 offset:34816
s_waitcnt vmcnt(6) lgkmcnt(8)
v_mfma_f32_16x16x32_bf16 v[64:67], v[48:51], v[216:219], v[64:67]
s_add_u32 s28, s42, 12288
buffer_load_dwordx4 v[248:251], v3, s[20:23], s28 offen sc1
buffer_load_dwordx4 v[252:255], v4, s[20:23], s28 offen sc1
ds_read_b64_tr_b16 v[32:33], v116 offset:40960
v_mfma_f32_16x16x32_bf16 v[68:71], v[48:51], v[220:223], v[68:71]
ds_read_b64_tr_b16 v[34:35], v116 offset:43008
v_mfma_f32_16x16x32_bf16 v[72:75], v[52:55], v[216:219], v[72:75]
ds_read_b64_tr_b16 v[36:37], v117 offset:40960
v_mfma_f32_16x16x32_bf16 v[76:79], v[52:55], v[220:223], v[76:79]
ds_read_b64_tr_b16 v[38:39], v117 offset:43008
v_mfma_f32_16x16x32_bf16 v[80:83], v[56:59], v[216:219], v[80:83]
ds_read_b64_tr_b16 v[40:41], v118 offset:40960
v_mfma_f32_16x16x32_bf16 v[84:87], v[56:59], v[220:223], v[84:87]
ds_read_b64_tr_b16 v[42:43], v118 offset:43008
v_mfma_f32_16x16x32_bf16 v[88:91], v[60:63], v[216:219], v[88:91]
ds_read_b64_tr_b16 v[44:45], v119 offset:40960
v_mfma_f32_16x16x32_bf16 v[92:95], v[60:63], v[220:223], v[92:95]
s_waitcnt lgkmcnt(14)
ds_read_b64_tr_b16 v[46:47], v119 offset:43008
s_waitcnt vmcnt(6) lgkmcnt(8)
v_mfma_f32_16x16x32_bf16 v[64:67], v[16:19], v[224:227], v[64:67]
ds_read_b64_tr_b16 v[48:49], v116 offset:49152
v_mfma_f32_16x16x32_bf16 v[68:71], v[16:19], v[228:231], v[68:71]
ds_read_b64_tr_b16 v[50:51], v116 offset:51200
v_mfma_f32_16x16x32_bf16 v[72:75], v[20:23], v[224:227], v[72:75]
ds_read_b64_tr_b16 v[52:53], v117 offset:49152
v_mfma_f32_16x16x32_bf16 v[76:79], v[20:23], v[228:231], v[76:79]
ds_read_b64_tr_b16 v[54:55], v117 offset:51200
v_mfma_f32_16x16x32_bf16 v[80:83], v[24:27], v[224:227], v[80:83]
ds_read_b64_tr_b16 v[56:57], v118 offset:49152
v_mfma_f32_16x16x32_bf16 v[84:87], v[24:27], v[228:231], v[84:87]
ds_read_b64_tr_b16 v[58:59], v118 offset:51200
v_mfma_f32_16x16x32_bf16 v[88:91], v[28:31], v[224:227], v[88:91]
ds_read_b64_tr_b16 v[60:61], v119 offset:49152
v_mfma_f32_16x16x32_bf16 v[92:95], v[28:31], v[228:231], v[92:95]
s_waitcnt lgkmcnt(14)
ds_read_b64_tr_b16 v[62:63], v119 offset:51200
s_waitcnt vmcnt(4) lgkmcnt(8)
v_mfma_f32_16x16x32_bf16 v[64:67], v[32:35], v[232:235], v[64:67]
ds_read_b64_tr_b16 v[16:17], v116 offset:57344
v_mfma_f32_16x16x32_bf16 v[68:71], v[32:35], v[236:239], v[68:71]
ds_read_b64_tr_b16 v[18:19], v116 offset:59392
v_mfma_f32_16x16x32_bf16 v[72:75], v[36:39], v[232:235], v[72:75]
ds_read_b64_tr_b16 v[20:21], v117 offset:57344
v_mfma_f32_16x16x32_bf16 v[76:79], v[36:39], v[236:239], v[76:79]
ds_read_b64_tr_b16 v[22:23], v117 offset:59392
v_mfma_f32_16x16x32_bf16 v[80:83], v[40:43], v[232:235], v[80:83]
ds_read_b64_tr_b16 v[24:25], v118 offset:57344
v_mfma_f32_16x16x32_bf16 v[84:87], v[40:43], v[236:239], v[84:87]
ds_read_b64_tr_b16 v[26:27], v118 offset:59392
v_mfma_f32_16x16x32_bf16 v[88:91], v[44:47], v[232:235], v[88:91]
ds_read_b64_tr_b16 v[28:29], v119 offset:57344
v_mfma_f32_16x16x32_bf16 v[92:95], v[44:47], v[236:239], v[92:95]
s_waitcnt lgkmcnt(14)
ds_read_b64_tr_b16 v[30:31], v119 offset:59392
s_waitcnt vmcnt(2) lgkmcnt(8)
v_mfma_f32_16x16x32_bf16 v[64:67], v[48:51], v[240:243], v[64:67]
v_mfma_f32_16x16x32_bf16 v[68:71], v[48:51], v[244:247], v[68:71]
v_mfma_f32_16x16x32_bf16 v[72:75], v[52:55], v[240:243], v[72:75]
v_mfma_f32_16x16x32_bf16 v[76:79], v[52:55], v[244:247], v[76:79]
v_mfma_f32_16x16x32_bf16 v[80:83], v[56:59], v[240:243], v[80:83]
v_mfma_f32_16x16x32_bf16 v[84:87], v[56:59], v[244:247], v[84:87]
v_mfma_f32_16x16x32_bf16 v[88:91], v[60:63], v[240:243], v[88:91]
v_mfma_f32_16x16x32_bf16 v[92:95], v[60:63], v[244:247], v[92:95]
s_waitcnt vmcnt(0) lgkmcnt(0)
v_mfma_f32_16x16x32_bf16 v[64:67], v[16:19], v[248:251], v[64:67]
v_mfma_f32_16x16x32_bf16 v[68:71], v[16:19], v[252:255], v[68:71]
v_mfma_f32_16x16x32_bf16 v[72:75], v[20:23], v[248:251], v[72:75]
v_mfma_f32_16x16x32_bf16 v[76:79], v[20:23], v[252:255], v[76:79]
v_mfma_f32_16x16x32_bf16 v[80:83], v[24:27], v[248:251], v[80:83]
v_mfma_f32_16x16x32_bf16 v[84:87], v[24:27], v[252:255], v[84:87]
v_mfma_f32_16x16x32_bf16 v[88:91], v[28:31], v[248:251], v[88:91]
v_mfma_f32_16x16x32_bf16 v[92:95], v[28:31], v[252:255], v[92:95]
s_lshl_b32 s29, s17, 2
s_add_u32 s29, s29, s16
s_lshl_b32 s29, s29, 7
s_add_u32 s44, s29, 16842752
s_lshl_b32 s29, s19, 2
s_add_u32 s29, s29, s31
s_lshl_b32 s29, s29, 2
v_mov_b32 v10, s29
v_mov_b32 v11, s50

v_cvt_pk_bf16_f32 v16, v64, v65
v_cvt_pk_bf16_f32 v17, v66, v67
v_cvt_pk_bf16_f32 v18, v68, v69
v_cvt_pk_bf16_f32 v19, v70, v71
buffer_store_dwordx4 v[16:19], v7, s[20:23], s100 offen offset:0 sc1
v_cvt_pk_bf16_f32 v20, v72, v73
v_cvt_pk_bf16_f32 v21, v74, v75
v_cvt_pk_bf16_f32 v22, v76, v77
v_cvt_pk_bf16_f32 v23, v78, v79
buffer_store_dwordx4 v[20:23], v7, s[20:23], s100 offen offset:1024 sc1
v_cvt_pk_bf16_f32 v24, v80, v81
v_cvt_pk_bf16_f32 v25, v82, v83
v_cvt_pk_bf16_f32 v26, v84, v85
v_cvt_pk_bf16_f32 v27, v86, v87
buffer_store_dwordx4 v[24:27], v7, s[20:23], s100 offen offset:2048 sc1
v_cvt_pk_bf16_f32 v28, v88, v89
v_cvt_pk_bf16_f32 v29, v90, v91
v_cvt_pk_bf16_f32 v30, v92, v93
v_cvt_pk_bf16_f32 v31, v94, v95
buffer_store_dwordx4 v[28:31], v7, s[20:23], s100 offen offset:3072 sc1
s_waitcnt vmcnt(0)
v_cmp_eq_u32 vcc, 0, v2
s_and_saveexec_b64 s[38:39], vcc
buffer_store_dword v11, v10, s[20:23], s44 offen sc1
s_mov_b64 exec, s[38:39]
s_cmp_ge_u32 s16, 3
s_cbranch_scc1 K_fin_skip
s_mov_b32 s24, s14
s_mov_b32 s25, s15
s_mov_b32 s26, 589824
s_mov_b32 s27, 0x20000
s_mov_b32 s54, 0xffff0000
s_cmp_eq_u32 s16, 2
s_cbranch_scc1 K_fin_ext

s_lshr_b32 s53, s19, 1
s_and_b32 s28, s19, 1
s_lshl_b32 s28, s28, 1
s_add_u32 s28, s28, s16
s_lshl_b32 s29, s17, 2
s_add_u32 s29, s29, s31
s_mul_i32 s42, s29, 24576
s_add_u32 s42, s42, 4194304
s_lshl_b32 s29, s53, 12
s_add_u32 s42, s42, s29
s_lshl_b32 s29, s28, 10
s_add_u32 s42, s42, s29
s_lshl_b32 s29, s17, 2
s_add_u32 s29, s29, s53
s_lshl_b32 s29, s29, 7
s_add_u32 s44, s29, 16842752
s_lshl_b32 s29, s31, 2
s_add_u32 s44, s44, s29
v_lshlrev_b32 v12, 4, v2
s_and_b32 s55, s53, 1
s_lshr_b32 s56, s53, 1
s_lshl_b32 s29, s56, 2
s_add_u32 s28, s28, s29
s_lshl_b32 s28, s28, 5
s_lshl_b32 s29, s31, 8
s_add_u32 s28, s28, s29
v_and_b32 v4, 15, v2
v_lshrrev_b32 v5, 4, v2
v_mul_u32_u24 v9, 1152, v4
v_lshl_add_u32 v9, v5, 3, v9
s_lshl_b32 s29, s17, 6
s_lshl_b32 s43, s55, 5
s_add_u32 s29, s29, s43
s_mul_i32 s29, s29, 1152
s_add_u32 s28, s28, s29
s_mul_i32 s29, s56, 18432
s_add_u32 s43, s28, s29
s_xor_b32 s29, s56, 1
s_mul_i32 s29, s29, 18432
s_add_u32 s46, s28, s29

s_mov_b32 s45, 0
v_cmp_gt_u32 vcc, 8, v2
s_and_b64 s[38:39], vcc, exec

K_poll2:
s_mov_b64 exec, s[38:39]
buffer_load_dword v10, v12, s[20:23], s44 offen sc1
s_waitcnt vmcnt(0)
v_cmp_ne_u32 vcc, s50, v10
s_mov_b64 exec, -1
s_cmp_eq_u64 vcc, 0
s_cbranch_scc1 K_polldone2
s_add_u32 s45, s45, 1
s_cmp_gt_u32 s45, 0x40000
s_cbranch_scc1 K_polldone2
s_sleep 1
s_branch K_poll2

K_polldone2:
s_add_u32 s28, s42, 0
buffer_load_dwordx4 v[16:19], v7, s[20:23], s28 offen sc1
s_add_u32 s28, s42, 786432
buffer_load_dwordx4 v[20:23], v7, s[20:23], s28 offen sc1
s_add_u32 s28, s42, 1572864
buffer_load_dwordx4 v[24:27], v7, s[20:23], s28 offen sc1
s_add_u32 s28, s42, 2359296
buffer_load_dwordx4 v[28:31], v7, s[20:23], s28 offen sc1
s_add_u32 s28, s42, 3145728
buffer_load_dwordx4 v[32:35], v7, s[20:23], s28 offen sc1
s_add_u32 s28, s42, 3932160
buffer_load_dwordx4 v[36:39], v7, s[20:23], s28 offen sc1
s_add_u32 s28, s42, 4718592
buffer_load_dwordx4 v[40:43], v7, s[20:23], s28 offen sc1
s_add_u32 s28, s42, 5505024
buffer_load_dwordx4 v[44:47], v7, s[20:23], s28 offen sc1
s_waitcnt vmcnt(7)
v_lshlrev_b32 v48, 16, v16
v_and_b32 v49, s54, v16
v_lshlrev_b32 v50, 16, v17
v_and_b32 v51, s54, v17
v_lshlrev_b32 v52, 16, v18
v_and_b32 v53, s54, v18
v_lshlrev_b32 v54, 16, v19
v_and_b32 v55, s54, v19
s_waitcnt vmcnt(6)
v_lshlrev_b32 v56, 16, v20
v_and_b32 v57, s54, v20
v_pk_add_f32 v[48:49], v[48:49], v[56:57]
v_lshlrev_b32 v56, 16, v21
v_and_b32 v57, s54, v21
v_pk_add_f32 v[50:51], v[50:51], v[56:57]
v_lshlrev_b32 v56, 16, v22
v_and_b32 v57, s54, v22
v_pk_add_f32 v[52:53], v[52:53], v[56:57]
v_lshlrev_b32 v56, 16, v23
v_and_b32 v57, s54, v23
v_pk_add_f32 v[54:55], v[54:55], v[56:57]
s_waitcnt vmcnt(5)
v_lshlrev_b32 v56, 16, v24
v_and_b32 v57, s54, v24
v_pk_add_f32 v[48:49], v[48:49], v[56:57]
v_lshlrev_b32 v56, 16, v25
v_and_b32 v57, s54, v25
v_pk_add_f32 v[50:51], v[50:51], v[56:57]
v_lshlrev_b32 v56, 16, v26
v_and_b32 v57, s54, v26
v_pk_add_f32 v[52:53], v[52:53], v[56:57]
v_lshlrev_b32 v56, 16, v27
v_and_b32 v57, s54, v27
v_pk_add_f32 v[54:55], v[54:55], v[56:57]
s_waitcnt vmcnt(4)
v_lshlrev_b32 v56, 16, v28
v_and_b32 v57, s54, v28
v_pk_add_f32 v[48:49], v[48:49], v[56:57]
v_lshlrev_b32 v56, 16, v29
v_and_b32 v57, s54, v29
v_pk_add_f32 v[50:51], v[50:51], v[56:57]
v_lshlrev_b32 v56, 16, v30
v_and_b32 v57, s54, v30
v_pk_add_f32 v[52:53], v[52:53], v[56:57]
v_lshlrev_b32 v56, 16, v31
v_and_b32 v57, s54, v31
v_pk_add_f32 v[54:55], v[54:55], v[56:57]
s_waitcnt vmcnt(3)
v_lshlrev_b32 v56, 16, v32
v_and_b32 v57, s54, v32
v_pk_add_f32 v[48:49], v[48:49], v[56:57]
v_lshlrev_b32 v56, 16, v33
v_and_b32 v57, s54, v33
v_pk_add_f32 v[50:51], v[50:51], v[56:57]
v_lshlrev_b32 v56, 16, v34
v_and_b32 v57, s54, v34
v_pk_add_f32 v[52:53], v[52:53], v[56:57]
v_lshlrev_b32 v56, 16, v35
v_and_b32 v57, s54, v35
v_pk_add_f32 v[54:55], v[54:55], v[56:57]
s_waitcnt vmcnt(2)
v_lshlrev_b32 v56, 16, v36
v_and_b32 v57, s54, v36
v_pk_add_f32 v[48:49], v[48:49], v[56:57]
v_lshlrev_b32 v56, 16, v37
v_and_b32 v57, s54, v37
v_pk_add_f32 v[50:51], v[50:51], v[56:57]
v_lshlrev_b32 v56, 16, v38
v_and_b32 v57, s54, v38
v_pk_add_f32 v[52:53], v[52:53], v[56:57]
v_lshlrev_b32 v56, 16, v39
v_and_b32 v57, s54, v39
v_pk_add_f32 v[54:55], v[54:55], v[56:57]
s_waitcnt vmcnt(1)
v_lshlrev_b32 v56, 16, v40
v_and_b32 v57, s54, v40
v_pk_add_f32 v[48:49], v[48:49], v[56:57]
v_lshlrev_b32 v56, 16, v41
v_and_b32 v57, s54, v41
v_pk_add_f32 v[50:51], v[50:51], v[56:57]
v_lshlrev_b32 v56, 16, v42
v_and_b32 v57, s54, v42
v_pk_add_f32 v[52:53], v[52:53], v[56:57]
v_lshlrev_b32 v56, 16, v43
v_and_b32 v57, s54, v43
v_pk_add_f32 v[54:55], v[54:55], v[56:57]
s_waitcnt vmcnt(0)
v_lshlrev_b32 v56, 16, v44
v_and_b32 v57, s54, v44
v_pk_add_f32 v[48:49], v[48:49], v[56:57]
v_lshlrev_b32 v56, 16, v45
v_and_b32 v57, s54, v45
v_pk_add_f32 v[50:51], v[50:51], v[56:57]
v_lshlrev_b32 v56, 16, v46
v_and_b32 v57, s54, v46
v_pk_add_f32 v[52:53], v[52:53], v[56:57]
v_lshlrev_b32 v56, 16, v47
v_and_b32 v57, s54, v47
v_pk_add_f32 v[54:55], v[54:55], v[56:57]
v_cvt_pk_bf16_f32 v60, v48, v49
v_cvt_pk_bf16_f32 v61, v50, v51
v_cvt_pk_bf16_f32 v62, v52, v53
v_cvt_pk_bf16_f32 v63, v54, v55
buffer_store_dwordx2 v[60:61], v9, s[24:27], s43 offen
buffer_store_dwordx2 v[62:63], v9, s[24:27], s46 offen
s_branch K_fin_skip
K_fin_ext:
s_lshl_b32 s28, s19, 2
s_add_u32 s28, s28, s31
s_lshr_b32 s53, s28, 3
s_bfe_u32 s55, s28, 0x10002
s_and_b32 s56, s28, 3
s_lshl_b32 s29, s17, 2
s_mul_i32 s42, s29, 24576
s_add_u32 s42, s42, 4210688
s_lshl_b32 s29, s53, 11
s_add_u32 s42, s42, s29
s_lshl_b32 s29, s55, 10
s_add_u32 s42, s42, s29
s_lshl_b32 s29, s56, 8
s_add_u32 s42, s42, s29
v_and_b32 v4, 15, v2
v_lshrrev_b32 v5, 4, v2
s_mov_b32 s29, 1572864
v_mul_lo_u32 v8, v5, s29
v_lshl_add_u32 v8, v4, 4, v8
s_lshl_b32 s29, s17, 2
s_add_u32 s29, s29, s53
s_lshl_b32 s29, s29, 7
s_add_u32 s44, s29, 16842752
v_lshlrev_b32 v12, 2, v2
s_and_b32 s57, s53, 1
s_lshr_b32 s53, s53, 1
s_lshl_b32 s28, s53, 1
s_add_u32 s28, s28, s55
s_lshl_b32 s28, s28, 5
s_lshl_b32 s29, s56, 3
s_add_u32 s28, s28, s29
s_add_u32 s28, s28, 1024
v_mul_u32_u24 v9, 1152, v4
s_lshl_b32 s29, s17, 6
s_lshl_b32 s43, s57, 5
s_add_u32 s29, s29, s43
s_mul_i32 s29, s29, 1152
s_add_u32 s28, s28, s29
s_mul_i32 s29, s53, 18432
s_add_u32 s43, s28, s29
s_xor_b32 s29, s53, 1
s_mul_i32 s29, s29, 18432
s_add_u32 s46, s28, s29

s_mov_b32 s45, 0
v_cmp_gt_u32 vcc, 32, v2
s_and_b64 s[38:39], vcc, exec

K_poll3:
s_mov_b64 exec, s[38:39]
buffer_load_dword v10, v12, s[20:23], s44 offen sc1
s_waitcnt vmcnt(0)
v_cmp_ne_u32 vcc, s50, v10
s_mov_b64 exec, -1
s_cmp_eq_u64 vcc, 0
s_cbranch_scc1 K_polldone3
s_add_u32 s45, s45, 1
s_cmp_gt_u32 s45, 0x40000
s_cbranch_scc1 K_polldone3
s_sleep 1
s_branch K_poll3

K_polldone3:
s_add_u32 s28, s42, 0
buffer_load_dwordx4 v[16:19], v8, s[20:23], s28 offen sc1
s_add_u32 s28, s42, 24576
buffer_load_dwordx4 v[20:23], v8, s[20:23], s28 offen sc1
s_add_u32 s28, s42, 49152
buffer_load_dwordx4 v[24:27], v8, s[20:23], s28 offen sc1
s_add_u32 s28, s42, 73728
buffer_load_dwordx4 v[28:31], v8, s[20:23], s28 offen sc1
s_add_u32 s28, s42, 786432
buffer_load_dwordx4 v[32:35], v8, s[20:23], s28 offen sc1
s_add_u32 s28, s42, 811008
buffer_load_dwordx4 v[36:39], v8, s[20:23], s28 offen sc1
s_add_u32 s28, s42, 835584
buffer_load_dwordx4 v[40:43], v8, s[20:23], s28 offen sc1
s_add_u32 s28, s42, 860160
buffer_load_dwordx4 v[44:47], v8, s[20:23], s28 offen sc1
s_waitcnt vmcnt(7)
v_lshlrev_b32 v48, 16, v16
v_and_b32 v49, s54, v16
v_lshlrev_b32 v50, 16, v17
v_and_b32 v51, s54, v17
v_lshlrev_b32 v52, 16, v18
v_and_b32 v53, s54, v18
v_lshlrev_b32 v54, 16, v19
v_and_b32 v55, s54, v19
s_waitcnt vmcnt(6)
v_lshlrev_b32 v56, 16, v20
v_and_b32 v57, s54, v20
v_pk_add_f32 v[48:49], v[48:49], v[56:57]
v_lshlrev_b32 v56, 16, v21
v_and_b32 v57, s54, v21
v_pk_add_f32 v[50:51], v[50:51], v[56:57]
v_lshlrev_b32 v56, 16, v22
v_and_b32 v57, s54, v22
v_pk_add_f32 v[52:53], v[52:53], v[56:57]
v_lshlrev_b32 v56, 16, v23
v_and_b32 v57, s54, v23
v_pk_add_f32 v[54:55], v[54:55], v[56:57]
s_waitcnt vmcnt(5)
v_lshlrev_b32 v56, 16, v24
v_and_b32 v57, s54, v24
v_pk_add_f32 v[48:49], v[48:49], v[56:57]
v_lshlrev_b32 v56, 16, v25
v_and_b32 v57, s54, v25
v_pk_add_f32 v[50:51], v[50:51], v[56:57]
v_lshlrev_b32 v56, 16, v26
v_and_b32 v57, s54, v26
v_pk_add_f32 v[52:53], v[52:53], v[56:57]
v_lshlrev_b32 v56, 16, v27
v_and_b32 v57, s54, v27
v_pk_add_f32 v[54:55], v[54:55], v[56:57]
s_waitcnt vmcnt(4)
v_lshlrev_b32 v56, 16, v28
v_and_b32 v57, s54, v28
v_pk_add_f32 v[48:49], v[48:49], v[56:57]
v_lshlrev_b32 v56, 16, v29
v_and_b32 v57, s54, v29
v_pk_add_f32 v[50:51], v[50:51], v[56:57]
v_lshlrev_b32 v56, 16, v30
v_and_b32 v57, s54, v30
v_pk_add_f32 v[52:53], v[52:53], v[56:57]
v_lshlrev_b32 v56, 16, v31
v_and_b32 v57, s54, v31
v_pk_add_f32 v[54:55], v[54:55], v[56:57]
s_waitcnt vmcnt(3)
v_lshlrev_b32 v56, 16, v32
v_and_b32 v57, s54, v32
v_pk_add_f32 v[48:49], v[48:49], v[56:57]
v_lshlrev_b32 v56, 16, v33
v_and_b32 v57, s54, v33
v_pk_add_f32 v[50:51], v[50:51], v[56:57]
v_lshlrev_b32 v56, 16, v34
v_and_b32 v57, s54, v34
v_pk_add_f32 v[52:53], v[52:53], v[56:57]
v_lshlrev_b32 v56, 16, v35
v_and_b32 v57, s54, v35
v_pk_add_f32 v[54:55], v[54:55], v[56:57]
s_waitcnt vmcnt(2)
v_lshlrev_b32 v56, 16, v36
v_and_b32 v57, s54, v36
v_pk_add_f32 v[48:49], v[48:49], v[56:57]
v_lshlrev_b32 v56, 16, v37
v_and_b32 v57, s54, v37
v_pk_add_f32 v[50:51], v[50:51], v[56:57]
v_lshlrev_b32 v56, 16, v38
v_and_b32 v57, s54, v38
v_pk_add_f32 v[52:53], v[52:53], v[56:57]
v_lshlrev_b32 v56, 16, v39
v_and_b32 v57, s54, v39
v_pk_add_f32 v[54:55], v[54:55], v[56:57]
s_waitcnt vmcnt(1)
v_lshlrev_b32 v56, 16, v40
v_and_b32 v57, s54, v40
v_pk_add_f32 v[48:49], v[48:49], v[56:57]
v_lshlrev_b32 v56, 16, v41
v_and_b32 v57, s54, v41
v_pk_add_f32 v[50:51], v[50:51], v[56:57]
v_lshlrev_b32 v56, 16, v42
v_and_b32 v57, s54, v42
v_pk_add_f32 v[52:53], v[52:53], v[56:57]
v_lshlrev_b32 v56, 16, v43
v_and_b32 v57, s54, v43
v_pk_add_f32 v[54:55], v[54:55], v[56:57]
s_waitcnt vmcnt(0)
v_lshlrev_b32 v56, 16, v44
v_and_b32 v57, s54, v44
v_pk_add_f32 v[48:49], v[48:49], v[56:57]
v_lshlrev_b32 v56, 16, v45
v_and_b32 v57, s54, v45
v_pk_add_f32 v[50:51], v[50:51], v[56:57]
v_lshlrev_b32 v56, 16, v46
v_and_b32 v57, s54, v46
v_pk_add_f32 v[52:53], v[52:53], v[56:57]
v_lshlrev_b32 v56, 16, v47
v_and_b32 v57, s54, v47
v_pk_add_f32 v[54:55], v[54:55], v[56:57]
v_mov_b32 v16, v48
v_mov_b32 v17, v49
v_mov_b32 v18, v50
v_mov_b32 v19, v51
v_mov_b32 v20, v52
v_mov_b32 v21, v53
v_mov_b32 v22, v54
v_mov_b32 v23, v55
s_nop 1
v_permlane16_swap_b32 v48, v16
v_permlane16_swap_b32 v49, v17
v_permlane16_swap_b32 v50, v18
v_permlane16_swap_b32 v51, v19
v_permlane16_swap_b32 v52, v20
v_permlane16_swap_b32 v53, v21
v_permlane16_swap_b32 v54, v22
v_permlane16_swap_b32 v55, v23
s_nop 1
v_add_f32 v48, v48, v16
v_add_f32 v49, v49, v17
v_add_f32 v50, v50, v18
v_add_f32 v51, v51, v19
v_add_f32 v52, v52, v20
v_add_f32 v53, v53, v21
v_add_f32 v54, v54, v22
v_add_f32 v55, v55, v23
v_mov_b32 v16, v48
v_mov_b32 v17, v49
v_mov_b32 v18, v50
v_mov_b32 v19, v51
v_mov_b32 v20, v52
v_mov_b32 v21, v53
v_mov_b32 v22, v54
v_mov_b32 v23, v55
s_nop 1
v_permlane32_swap_b32 v48, v16
v_permlane32_swap_b32 v49, v17
v_permlane32_swap_b32 v50, v18
v_permlane32_swap_b32 v51, v19
v_permlane32_swap_b32 v52, v20
v_permlane32_swap_b32 v53, v21
v_permlane32_swap_b32 v54, v22
v_permlane32_swap_b32 v55, v23
s_nop 1
v_add_f32 v48, v48, v16
v_add_f32 v49, v49, v17
v_add_f32 v50, v50, v18
v_add_f32 v51, v51, v19
v_add_f32 v52, v52, v20
v_add_f32 v53, v53, v21
v_add_f32 v54, v54, v22
v_add_f32 v55, v55, v23
v_cvt_pk_bf16_f32 v60, v48, v49
v_cvt_pk_bf16_f32 v61, v50, v51
v_cvt_pk_bf16_f32 v62, v52, v53
v_cvt_pk_bf16_f32 v63, v54, v55
v_cmp_gt_u32 vcc, 16, v2
s_and_saveexec_b64 s[38:39], vcc
buffer_store_dwordx2 v[60:61], v9, s[24:27], s43 offen
buffer_store_dwordx2 v[62:63], v9, s[24:27], s46 offen
s_mov_b64 exec, s[38:39]

K_fin_skip:
K_end:
s_endpgm
K_codeend:
.section .rodata,"a"
.p2align 6
.amdhsa_kernel standalone__gqa_block_cached__near_ridge_kernel
  .amdhsa_next_free_vgpr 256
  .amdhsa_next_free_sgpr 102
  .amdhsa_accum_offset 256
  .amdhsa_group_segment_fixed_size 0
  .amdhsa_kernarg_size 64
  .amdhsa_user_sgpr_count 2
  .amdhsa_user_sgpr_kernarg_segment_ptr 1
  .amdhsa_system_sgpr_workgroup_id_x 1
.end_amdhsa_kernel
```
